```python
import torch

def _softmax(x, axis=-1):
    return torch.softmax(x, dim=axis)
def _gelu(x):
    return torch.nn.functional.gelu(x, approximate="tanh")
def _silu(x):
    return torch.nn.functional.silu(x)
def _sigmoid(x):
    return torch.sigmoid(x)
def _layernorm(x, axis=-1, eps=1e-5):
    m = x.mean(dim=axis, keepdim=True)
    v = x.var(dim=axis, keepdim=True, unbiased=False)
    return (x - m) / torch.sqrt(v + eps)
def _scatter_add(tgt, idx, src, axis=0):
    return tgt.clone().index_add_(axis, idx, src)
def _segment_sum(src, seg, n):
    out = torch.zeros((n,) + src.shape[1:], dtype=src.dtype)
    return out.index_add_(0, seg, src)
def _pad(x, pw):
    flat = tuple(v for pair in reversed(pw) for v in pair)
    return torch.nn.functional.pad(x, flat)

kernel_name = 'recurrent_scan__sliding_block_cached__glu_gated_swiglu__decode'

def setup_inputs():

    _w = (lambda a: (lambda t: t.to(torch.bfloat16) if t.is_floating_point() else t)(torch.as_tensor(a)))
    def _A_setup():
        B, Sq, D = 4, 1, 512
        Hq, Hkv, Sk, Dh = 32, 8, 4096, 128
        assert Hq % Hkv == 0, (Hq, Hkv)
        return {
            "x": _w((lambda *s: torch.randn(*s, dtype=torch.bfloat16) * 0.05)(B, Sq, D)),
            "k_cache": _w((lambda *s: torch.randn(*s, dtype=torch.bfloat16) * 1.6)(B, Hkv, Sk, Dh)),
            "v_cache": _w((lambda *s: torch.randn(*s, dtype=torch.bfloat16) * 1.6)(B, Hkv, Sk, Dh)),
            "wq": _w((lambda *s: torch.randn(*s, dtype=torch.bfloat16) * 1.6)(D, Hq * Dh) * (D ** -0.5)),
            "wo": _w((lambda *s: torch.randn(*s, dtype=torch.bfloat16) * 1.6)(Hq * Dh, D) * ((Hq * Dh) ** -0.5)),
        }
    _A_in = _A_setup()

    def _B_setup():
        B, S, D, F = 4, 1, 512, 1792
        return {
            "x": _w((lambda *s: torch.randn(*s, dtype=torch.bfloat16) * 0.05)(B, S, D)),
            "w1": _w((lambda *s: torch.randn(*s, dtype=torch.bfloat16) * 0.2)(D, F) * (2.0 / D) ** 0.5),
            "w3": _w((lambda *s: torch.randn(*s, dtype=torch.bfloat16) * 0.2)(D, F) * (2.0 / D) ** 0.5),
            "w2": _w((lambda *s: torch.randn(*s, dtype=torch.bfloat16) * 0.2)(F, D) * (2.0 / F) ** 0.5),
        }
    _B_in = _B_setup()

    return {
        "A_x": _A_in["x"],
        "A_k_cache": _A_in["k_cache"],
        "A_v_cache": _A_in["v_cache"],
        "A_wq": _A_in["wq"],
        "A_wo": _A_in["wo"],
        "B_x": _B_in["x"],
        "B_w1": _B_in["w1"],
        "B_w3": _B_in["w3"],
        "B_w2": _B_in["w2"],
    }

def reference(A_x, A_k_cache, A_v_cache, A_wq, A_wo, B_x, B_w1, B_w3, B_w2):
    def _A_ref(x, k_cache, v_cache, wq, wo):
        B, Sq, D = x.shape
        Hq, Dh = 32, 128
        Hkv, Sk = k_cache.shape[1], k_cache.shape[2]
        W = min(4096, max(256, Sk // 4))
        rep = Hq // Hkv
        q = (lambda x, *d: x.permute(*d))((x @ wq).reshape(B, Sq, Hq, Dh), 0, 2, 1, 3)
        k = (lambda x, n, axis: torch.repeat_interleave(x, n, dim=axis))(k_cache[:, :, Sk - W:, :], rep, axis=1)
        v = (lambda x, n, axis: torch.repeat_interleave(x, n, dim=axis))(v_cache[:, :, Sk - W:, :], rep, axis=1)
        scores = torch.einsum("bhqd,bhkd->bhqk", q, k) * (Dh ** -0.5)
        p = _softmax(scores, axis=-1)
        o = torch.einsum("bhqk,bhkd->bhqd", p, v)
        return (lambda x, *d: x.permute(*d))(o, 0, 2, 1, 3).reshape(B, Sq, Hq * Dh) @ wo

    def _B_ref(x, w1, w3, w2):
        gate = torch.einsum("bsd,df->bsf", x, w1)
        up = torch.einsum("bsd,df->bsf", x, w3)
        h = _silu(gate) * up
        out = torch.einsum("bsf,fd->bsd", h, w2)
        return out

    x = A_x
    xn = _layernorm(x, axis=-1)
    s = _A_ref(xn, A_k_cache, A_v_cache, A_wq, A_wo)
    g = _silu(_B_ref(xn, B_w1, B_w3, B_w2))
    return x + s * g
```

```asm
; @launch grid=(256,1,1) block=(448,1,1) lds=132992
.amdgcn_target "amdgcn-amd-amdhsa--gfx950"
.text
.globl recurrent_scan__sliding_block_cached__glu_gated_swiglu__decode_kernel
.p2align 12
.fill 832, 4, 0xbf800000
.p2align 8
.type recurrent_scan__sliding_block_cached__glu_gated_swiglu__decode_kernel,@function
recurrent_scan__sliding_block_cached__glu_gated_swiglu__decode_kernel:
  s_load_dwordx16 s[8:23], s[0:1], 0
  s_load_dwordx8 s[24:31], s[0:1], 64
  s_cmp_ge_u32 s2, 256
  s_cbranch_scc1 L_end
  v_lshrrev_b32 v1, 6, v0
  v_and_b32 v0, 63, v0
  v_readfirstlane_b32 s3, v1
  s_and_b32 s4, s2, 7
  s_lshr_b32 s5, s2, 3
  v_lshrrev_b32 v1, 4, v0
  v_and_b32 v2, 15, v0
  s_lshr_b32 s38, s5, 3
  s_and_b32 s39, s5, 7
  s_xor_b32 s6, s39, 4
  s_cmp_eq_u32 s3, 0
  s_cbranch_scc1 L_LN
  s_cmp_eq_u32 s3, 6
  s_cbranch_scc1 L_PR
  v_and_b32 v3, 1, v1
  v_lshlrev_b32 v3, 1, v3
  v_and_b32 v4, 7, v0
  v_xor_b32 v3, v3, v4
  v_lshlrev_b32 v3, 4, v3
  v_lshrrev_b32 v4, 3, v0
  s_cmp_eq_u32 s3, 5
  s_cbranch_scc1 L_LD
  s_setprio 2
  s_sub_u32 s37, s3, 1
  s_lshl_b32 s56, s38, 2
  s_add_u32 s56, s56, s37
  s_lshl_b32 s56, s56, 8
  s_add_u32 s56, s56, s4
  s_lshl_b32 s56, s56, 3
  s_add_u32 s56, s56, s6
  s_lshl_b32 s56, s56, 7
  s_lshl_b32 m0, s37, 12
  v_lshl_add_u32 v6, v4, 13, v3
  v_xor_b32 v7, 64, v6
  v_add_u32 v7, 64512, v7
  v_add_u32 v8, 129024, v6
  v_add_u32 v9, 129024, v7
  s_waitcnt lgkmcnt(0)
  s_add_u32 s42, s14, s56
  s_addc_u32 s43, s15, 0
  global_load_lds_dwordx4 v6, s[42:43] offset:0 nt
  global_load_lds_dwordx4 v7, s[42:43] offset:1024 nt
  global_load_lds_dwordx4 v8, s[42:43] offset:2048 nt
  global_load_lds_dwordx4 v9, s[42:43] offset:3072 nt
  s_barrier
  s_bfm_b32 s56, s4, 0
  s_and_b32 s56, s56, 48
  s_bcnt1_i32_b32 s56, s56
  s_lshl_b32 s41, s4, 1
  s_sub_u32 s41, s41, s56
  s_lshr_b32 s56, s38, 1
  s_lshr_b32 s7, s39, 1
  s_bfe_u32 s57, s5, 0x30001
  s_lshr_b32 s63, 48, s4
  s_andn2_b32 s63, 1, s63
  s_cselect_b32 s56, s38, s56
  s_cselect_b32 s7, s7, s57
  s_lshl1_add_u32 s41, s41, s56
  s_load_dword s32, s[30:31], 0
  s_branch L_Q2
L_LN:
  s_setprio 3
  v_lshlrev_b32 v3, 4, v0
  s_getpc_b64 s[42:43]
L_pc:
  s_lshl_b32 s56, s5, 10
  s_cmp_ge_u32 s56, L_codeend-L_pc
  s_cbranch_scc1 L_nopf
  v_add_u32 v4, s56, v3
  global_load_dwordx4 v[16:19], v4, s[42:43]
L_nopf:
  v_lshlrev_b32 v4, 10, v1
  v_lshl_add_u32 v4, v2, 4, v4
  v_mov_b32 v68, 0
  v_mov_b32 v69, 0
  v_mov_b32 v70, 0
  v_mov_b32 v71, 0
  v_add_u32 v3, 127232, v3
  ds_write_b128 v3, v[68:71]
  ds_write_b128 v3, v[68:71] offset:64
  s_waitcnt lgkmcnt(0)
  global_load_dwordx4 v[20:23], v4, s[8:9] offset:0
  global_load_dwordx4 v[24:27], v4, s[8:9] offset:256
  global_load_dwordx4 v[28:31], v4, s[8:9] offset:512
  global_load_dwordx4 v[32:35], v4, s[8:9] offset:768
  s_bfm_b32 s56, s4, 0
  s_and_b32 s56, s56, 48
  s_bcnt1_i32_b32 s56, s56
  s_lshl_b32 s41, s4, 1
  s_sub_u32 s41, s41, s56
  s_lshr_b32 s56, s38, 1
  s_lshr_b32 s7, s39, 1
  s_bfe_u32 s57, s5, 0x30001
  s_lshr_b32 s63, 48, s4
  s_andn2_b32 s63, 1, s63
  s_cselect_b32 s56, s38, s56
  s_cselect_b32 s7, s7, s57
  s_lshl1_add_u32 s41, s41, s56
  s_lshl_b32 s56, s4, 4
  s_add_u32 s56, s56, s38
  s_lshl_b32 s56, s56, 3
  s_add_u32 s56, s56, s6
  s_lshl_b32 s56, s56, 8
  s_add_u32 s56, s56, 4096
  v_bfe_u32 v5, v0, 1, 2
  v_and_b32 v6, 1, v0
  v_lshlrev_b32 v6, 7, v6
  v_lshl_add_u32 v7, v5, 13, v6
  v_add_u32 v7, s56, v7
  s_and_b32 s56, s39, 1
  s_lshl_b32 s56, s56, 5
  s_add_u32 s56, s56, s7
  s_mul_i32 s56, s56, 7168
  s_lshl_b32 s57, s41, 8
  s_add_u32 s56, s56, s57
  s_add_u32 s56, s56, 266240
  v_mul_u32_u24 v5, 57344, v5
  v_add3_u32 v5, v5, v6, s56
  v_cmp_gt_u32 vcc, 8, v0
  s_mov_b64 exec, 0xffff
  s_nop 0
  v_cndmask_b32 v7, v5, v7, vcc
  global_load_dword v16, v7, s[30:31]
  s_mov_b64 exec, -1
  s_barrier
  s_branch L_LN2
L_LD:
  s_bfm_b32 s56, s4, 0
  s_and_b32 s56, s56, 48
  s_bcnt1_i32_b32 s56, s56
  s_lshl_b32 s41, s4, 1
  s_sub_u32 s41, s41, s56
  s_lshr_b32 s56, s38, 1
  s_lshr_b32 s7, s39, 1
  s_bfe_u32 s57, s5, 0x30001
  s_lshr_b32 s63, 48, s4
  s_andn2_b32 s63, 1, s63
  s_cselect_b32 s56, s38, s56
  s_cselect_b32 s7, s7, s57
  s_lshl1_add_u32 s41, s41, s56
  s_lshl_b32 s56, s7, s63
  s_mul_i32 s56, s56, 229376
  s_lshl_b32 s59, s41, 7
  s_add_u32 s56, s56, s59
  v_mul_u32_u24 v28, 3584, v4
  v_add_u32 v28, v28, v3
  v_xor_b32 v29, 64, v28
  v_add_u32 v29, 27648, v29
  v_add_u32 v30, 55296, v28
  v_add_u32 v31, 55296, v29
  s_mov_b32 m0, 16384
  s_bitcmp0_b32 s39, 0
  s_waitcnt lgkmcnt(0)
  s_cselect_b64 s[46:47], s[20:21], s[22:23]
  s_add_u32 s46, s46, s56
  s_addc_u32 s47, s47, 0
  s_barrier
L_LD2:
  s_mov_b32 m0, 16384
  s_nop 0
  global_load_lds_dwordx4 v28, s[46:47] offset:0 nt
  global_load_lds_dwordx4 v29, s[46:47] offset:1024 nt
  global_load_lds_dwordx4 v30, s[46:47] offset:2048 nt
  global_load_lds_dwordx4 v31, s[46:47] offset:3072 nt
  s_mov_b32 m0, 20480
  s_add_u32 s46, s46, 114688
  s_addc_u32 s47, s47, 0
  global_load_lds_dwordx4 v28, s[46:47] offset:0 nt
  global_load_lds_dwordx4 v29, s[46:47] offset:1024 nt
  global_load_lds_dwordx4 v30, s[46:47] offset:2048 nt
  global_load_lds_dwordx4 v31, s[46:47] offset:3072 nt
  s_cmp_eq_u32 s63, 0
  s_cbranch_scc1 L_skip8
  s_mov_b32 m0, 24576
  s_add_u32 s46, s46, 114688
  s_addc_u32 s47, s47, 0
  global_load_lds_dwordx4 v28, s[46:47] offset:0 nt
  global_load_lds_dwordx4 v29, s[46:47] offset:1024 nt
  global_load_lds_dwordx4 v30, s[46:47] offset:2048 nt
  global_load_lds_dwordx4 v31, s[46:47] offset:3072 nt
L_skip8:
  s_cmp_eq_u32 s63, 0
  s_cbranch_scc1 L_skip12
  s_mov_b32 m0, 28672
  s_add_u32 s46, s46, 114688
  s_addc_u32 s47, s47, 0
  global_load_lds_dwordx4 v28, s[46:47] offset:0 nt
  global_load_lds_dwordx4 v29, s[46:47] offset:1024 nt
  global_load_lds_dwordx4 v30, s[46:47] offset:2048 nt
  global_load_lds_dwordx4 v31, s[46:47] offset:3072 nt
L_skip12:
  s_lshl_b32 s57, s38, 3
  s_add_u32 s57, s57, s4
  s_lshl_b32 s57, s57, 20
  s_add_u32 s57, s57, 790528
  s_add_u32 s42, s10, s57
  s_addc_u32 s43, s11, 0
  s_add_u32 s44, s12, s57
  s_addc_u32 s45, s13, 0
  v_xor_b32 v6, v1, v2
  v_lshlrev_b32 v6, 4, v6
  v_lshl_add_u32 v8, v1, 8, v6
  v_xor_b32 v9, 64, v8
  v_xor_b32 v10, 128, v8
  v_xor_b32 v11, 192, v8
  v_lshlrev_b32 v6, 1, v1
  v_xor_b32 v6, v6, v2
  v_lshlrev_b32 v6, 4, v6
  v_lshl_add_u32 v32, v1, 8, v6
  v_xor_b32 v33, 0x80, v32
  v_lshl_add_u32 v34, v4, 10, v3
  v_xor_b32 v35, 64, v34
  v_add_u32 v35, 7168, v35
  v_add_u32 v36, 14336, v34
  v_add_u32 v37, 14336, v35
  s_lshl_b32 s60, s39, 7
  s_lshl_b32 s56, s41, 16
  s_add_u32 s56, s56, s60
  s_and_b32 s57, s38, 1
  s_lshl_b32 s57, s57, 15
  s_lshl_b32 s18, s63, 15
  s_cselect_b32 s57, 0, s57
  s_add_u32 s56, s56, s57
  s_add_u32 s48, s24, s56
  s_addc_u32 s49, s25, 0
  s_lshl_b32 s56, s4, 2
  s_add_u32 s56, s56, s38
  s_lshl_b32 s56, s56, 17
  s_add_u32 s56, s56, s60
  s_add_u32 s50, s16, s56
  s_addc_u32 s51, s17, 0
  v_mov_b32 v15, 128256
  v_mov_b32 v16, 1
  s_mov_b32 s64, 0x200000
  s_load_dword s32, s[30:31], 0
  s_mov_b32 s61, 0
  s_add_u32 s56, s39, 0
  s_and_b32 s56, s56, 7
  s_lshl_b32 s56, s56, 12
  s_add_u32 s56, s56, 0
  s_mov_b32 m0, 94208
  s_add_u32 s52, s42, s56
  s_addc_u32 s53, s43, 0
  global_load_lds_dwordx4 v8, s[52:53] offset:-4096 nt
  global_load_lds_dwordx4 v9, s[52:53] offset:-3072 nt
  global_load_lds_dwordx4 v10, s[52:53] offset:-2048 nt
  global_load_lds_dwordx4 v11, s[52:53] offset:-1024 nt
  s_add_u32 s56, s39, 1
  s_and_b32 s56, s56, 7
  s_lshl_b32 s56, s56, 12
  s_add_u32 s56, s56, 32768
  s_mov_b32 m0, 98304
  s_add_u32 s52, s42, s56
  s_addc_u32 s53, s43, 0
  global_load_lds_dwordx4 v8, s[52:53] offset:-4096 nt
  global_load_lds_dwordx4 v9, s[52:53] offset:-3072 nt
  global_load_lds_dwordx4 v10, s[52:53] offset:-2048 nt
  global_load_lds_dwordx4 v11, s[52:53] offset:-1024 nt
  s_waitcnt vmcnt(23)
  s_add_u32 s56, s39, 2
  s_and_b32 s56, s56, 7
  s_lshl_b32 s56, s56, 12
  s_add_u32 s56, s56, 65536
  s_mov_b32 m0, 102400
  s_add_u32 s52, s42, s56
  s_addc_u32 s53, s43, 0
  global_load_lds_dwordx4 v8, s[52:53] offset:-4096 nt
  s_waitcnt vmcnt(23)
  global_load_lds_dwordx4 v9, s[52:53] offset:-3072 nt
  s_waitcnt vmcnt(23)
  global_load_lds_dwordx4 v10, s[52:53] offset:-2048 nt
  s_waitcnt vmcnt(23)
  global_load_lds_dwordx4 v11, s[52:53] offset:-1024 nt
  s_waitcnt vmcnt(23)
  s_add_u32 s56, s39, 3
  s_and_b32 s56, s56, 7
  s_lshl_b32 s56, s56, 12
  s_add_u32 s56, s56, 98304
  s_mov_b32 m0, 106496
  s_add_u32 s52, s42, s56
  s_addc_u32 s53, s43, 0
  global_load_lds_dwordx4 v8, s[52:53] offset:-4096 nt
  s_waitcnt vmcnt(23)
  global_load_lds_dwordx4 v9, s[52:53] offset:-3072 nt
  s_waitcnt vmcnt(23)
  global_load_lds_dwordx4 v10, s[52:53] offset:-2048 nt
  s_waitcnt vmcnt(23)
  global_load_lds_dwordx4 v11, s[52:53] offset:-1024 nt
  s_waitcnt vmcnt(23)
  s_add_u32 s56, s39, 4
  s_and_b32 s56, s56, 7
  s_lshl_b32 s56, s56, 12
  s_add_u32 s56, s56, 131072
  s_mov_b32 m0, 110592
  s_add_u32 s52, s42, s56
  s_addc_u32 s53, s43, 0
  global_load_lds_dwordx4 v8, s[52:53] offset:-4096 nt
  s_waitcnt vmcnt(23)
  global_load_lds_dwordx4 v9, s[52:53] offset:-3072 nt
  s_waitcnt vmcnt(23)
  global_load_lds_dwordx4 v10, s[52:53] offset:-2048 nt
  s_waitcnt vmcnt(23)
  global_load_lds_dwordx4 v11, s[52:53] offset:-1024 nt
  s_waitcnt vmcnt(23)
  s_add_u32 s56, s39, 5
  s_and_b32 s56, s56, 7
  s_lshl_b32 s56, s56, 12
  s_add_u32 s56, s56, 163840
  s_mov_b32 m0, 114688
  s_add_u32 s52, s42, s56
  s_addc_u32 s53, s43, 0
  global_load_lds_dwordx4 v8, s[52:53] offset:-4096 nt
  s_waitcnt vmcnt(23)
  global_load_lds_dwordx4 v9, s[52:53] offset:-3072 nt
  s_waitcnt vmcnt(23)
  global_load_lds_dwordx4 v10, s[52:53] offset:-2048 nt
  s_waitcnt vmcnt(23)
  s_waitcnt lgkmcnt(0)
  s_mov_b64 exec, 1
  ds_add_u32 v15, v16 offset:4
  s_mov_b64 exec, -1
  global_load_lds_dwordx4 v11, s[52:53] offset:-1024 nt
  s_waitcnt vmcnt(23)
  s_add_u32 s56, s39, 6
  s_and_b32 s56, s56, 7
  s_lshl_b32 s56, s56, 12
  s_add_u32 s56, s56, 196608
  s_mov_b32 m0, 118784
  s_add_u32 s52, s42, s56
  s_addc_u32 s53, s43, 0
  global_load_lds_dwordx4 v8, s[52:53] offset:-4096 nt
  s_waitcnt vmcnt(23)
  global_load_lds_dwordx4 v9, s[52:53] offset:-3072 nt
  s_waitcnt vmcnt(23)
  global_load_lds_dwordx4 v10, s[52:53] offset:-2048 nt
  s_waitcnt vmcnt(23)
  global_load_lds_dwordx4 v11, s[52:53] offset:-1024 nt
  s_waitcnt vmcnt(23)
  s_add_u32 s56, s39, 7
  s_and_b32 s56, s56, 7
  s_lshl_b32 s56, s56, 12
  s_add_u32 s56, s56, 229376
  s_mov_b32 m0, 122880
  s_add_u32 s52, s42, s56
  s_addc_u32 s53, s43, 0
  global_load_lds_dwordx4 v8, s[52:53] offset:-4096 nt
  s_waitcnt vmcnt(23)
  global_load_lds_dwordx4 v9, s[52:53] offset:-3072 nt
  s_waitcnt vmcnt(23)
  global_load_lds_dwordx4 v10, s[52:53] offset:-2048 nt
  s_waitcnt vmcnt(23)
  global_load_lds_dwordx4 v11, s[52:53] offset:-1024 nt
  s_waitcnt vmcnt(23)
  s_add_u32 s56, s39, 0
  s_and_b32 s56, s56, 7
  s_lshl_b32 s56, s56, 12
  s_add_u32 s56, s56, 0
  s_mov_b32 m0, 36864
  s_add_u32 s52, s44, s56
  s_addc_u32 s53, s45, 0
  global_load_lds_dwordx4 v32, s[52:53] offset:-4096 nt
  s_waitcnt vmcnt(23)
  global_load_lds_dwordx4 v33, s[52:53] offset:-3072 nt
  s_waitcnt vmcnt(23)
  global_load_lds_dwordx4 v32, s[52:53] offset:-2048 nt
  s_waitcnt vmcnt(23)
  global_load_lds_dwordx4 v33, s[52:53] offset:-1024 nt
  s_waitcnt vmcnt(23)
  s_add_u32 s56, s39, 1
  s_and_b32 s56, s56, 7
  s_lshl_b32 s56, s56, 12
  s_add_u32 s56, s56, 32768
  s_mov_b32 m0, 40960
  s_add_u32 s52, s44, s56
  s_addc_u32 s53, s45, 0
  global_load_lds_dwordx4 v32, s[52:53] offset:-4096 nt
  s_waitcnt vmcnt(23)
  global_load_lds_dwordx4 v33, s[52:53] offset:-3072 nt
  s_waitcnt vmcnt(23)
  global_load_lds_dwordx4 v32, s[52:53] offset:-2048 nt
  s_waitcnt vmcnt(23)
  global_load_lds_dwordx4 v33, s[52:53] offset:-1024 nt
  s_waitcnt vmcnt(23)
  s_add_u32 s56, s39, 2
  s_and_b32 s56, s56, 7
  s_lshl_b32 s56, s56, 12
  s_add_u32 s56, s56, 65536
  s_mov_b32 m0, 45056
  s_add_u32 s52, s44, s56
  s_addc_u32 s53, s45, 0
  global_load_lds_dwordx4 v32, s[52:53] offset:-4096 nt
  s_waitcnt vmcnt(23)
  global_load_lds_dwordx4 v33, s[52:53] offset:-3072 nt
  s_waitcnt vmcnt(23)
  global_load_lds_dwordx4 v32, s[52:53] offset:-2048 nt
  s_waitcnt vmcnt(23)
  global_load_lds_dwordx4 v33, s[52:53] offset:-1024 nt
  s_waitcnt vmcnt(23)
  s_add_u32 s56, s39, 3
  s_and_b32 s56, s56, 7
  s_lshl_b32 s56, s56, 12
  s_add_u32 s56, s56, 98304
  s_mov_b32 m0, 49152
  s_add_u32 s52, s44, s56
  s_addc_u32 s53, s45, 0
  global_load_lds_dwordx4 v32, s[52:53] offset:-4096 nt
  s_waitcnt vmcnt(23)
  global_load_lds_dwordx4 v33, s[52:53] offset:-3072 nt
  s_waitcnt vmcnt(23)
  global_load_lds_dwordx4 v32, s[52:53] offset:-2048 nt
  s_waitcnt vmcnt(23)
  global_load_lds_dwordx4 v33, s[52:53] offset:-1024 nt
  s_waitcnt vmcnt(23)
  s_add_u32 s56, s39, 4
  s_and_b32 s56, s56, 7
  s_lshl_b32 s56, s56, 12
  s_add_u32 s56, s56, 131072
  s_mov_b32 m0, 53248
  s_add_u32 s52, s44, s56
  s_addc_u32 s53, s45, 0
  global_load_lds_dwordx4 v32, s[52:53] offset:-4096 nt
  s_waitcnt vmcnt(23)
  global_load_lds_dwordx4 v33, s[52:53] offset:-3072 nt
  s_waitcnt vmcnt(23)
  global_load_lds_dwordx4 v32, s[52:53] offset:-2048 nt
  s_waitcnt vmcnt(23)
  global_load_lds_dwordx4 v33, s[52:53] offset:-1024 nt
  s_waitcnt vmcnt(23)
  s_add_u32 s56, s39, 5
  s_and_b32 s56, s56, 7
  s_lshl_b32 s56, s56, 12
  s_add_u32 s56, s56, 163840
  s_mov_b32 m0, 57344
  s_add_u32 s52, s44, s56
  s_addc_u32 s53, s45, 0
  global_load_lds_dwordx4 v32, s[52:53] offset:-4096 nt
  s_waitcnt vmcnt(23)
  global_load_lds_dwordx4 v33, s[52:53] offset:-3072 nt
  s_waitcnt vmcnt(23)
  global_load_lds_dwordx4 v32, s[52:53] offset:-2048 nt
  s_waitcnt vmcnt(23)
  s_mov_b64 exec, 1
  ds_add_u32 v15, v16 offset:8
  s_mov_b64 exec, -1
  global_load_lds_dwordx4 v33, s[52:53] offset:-1024 nt
  s_waitcnt vmcnt(23)
  s_add_u32 s56, s39, 6
  s_and_b32 s56, s56, 7
  s_lshl_b32 s56, s56, 12
  s_add_u32 s56, s56, 196608
  s_mov_b32 m0, 61440
  s_add_u32 s52, s44, s56
  s_addc_u32 s53, s45, 0
  global_load_lds_dwordx4 v32, s[52:53] offset:-4096 nt
  s_waitcnt vmcnt(23)
  global_load_lds_dwordx4 v33, s[52:53] offset:-3072 nt
  s_waitcnt vmcnt(23)
  global_load_lds_dwordx4 v32, s[52:53] offset:-2048 nt
  s_waitcnt vmcnt(23)
  global_load_lds_dwordx4 v33, s[52:53] offset:-1024 nt
  s_waitcnt vmcnt(23)
  s_add_u32 s56, s39, 7
  s_and_b32 s56, s56, 7
  s_lshl_b32 s56, s56, 12
  s_add_u32 s56, s56, 229376
  s_mov_b32 m0, 65536
  s_add_u32 s52, s44, s56
  s_addc_u32 s53, s45, 0
  global_load_lds_dwordx4 v32, s[52:53] offset:-4096 nt
  s_waitcnt vmcnt(23)
  global_load_lds_dwordx4 v33, s[52:53] offset:-3072 nt
  s_waitcnt vmcnt(23)
  global_load_lds_dwordx4 v32, s[52:53] offset:-2048 nt
  s_waitcnt vmcnt(23)
  s_mov_b64 exec, 1
  ds_add_u32 v15, v16 offset:20
  s_mov_b64 exec, -1
  global_load_lds_dwordx4 v33, s[52:53] offset:-1024 nt
  s_waitcnt vmcnt(23)
  s_mov_b32 m0, 81920
  s_nop 0
  global_load_lds_dwordx4 v34, s[48:49] offset:0 nt
  s_waitcnt vmcnt(23)
  global_load_lds_dwordx4 v35, s[48:49] offset:1024 nt
  s_waitcnt vmcnt(23)
  global_load_lds_dwordx4 v36, s[48:49] offset:2048 nt
  s_waitcnt vmcnt(23)
  global_load_lds_dwordx4 v37, s[48:49] offset:3072 nt
  s_waitcnt vmcnt(23)
  s_mov_b32 m0, 86016
  s_add_u32 s48, s48, s18
  s_addc_u32 s49, s49, 0
  global_load_lds_dwordx4 v34, s[48:49] offset:0 nt
  s_waitcnt vmcnt(23)
  global_load_lds_dwordx4 v35, s[48:49] offset:1024 nt
  s_waitcnt vmcnt(23)
  global_load_lds_dwordx4 v36, s[48:49] offset:2048 nt
  s_waitcnt vmcnt(23)
  s_mov_b64 exec, 1
  ds_add_u32 v15, v16 offset:20
  s_mov_b64 exec, -1
  global_load_lds_dwordx4 v37, s[48:49] offset:3072 nt
  s_waitcnt vmcnt(23)
  s_mov_b32 m0, 65536
  s_nop 0
  global_load_lds_dwordx4 v34, s[50:51] offset:0 nt
  s_waitcnt vmcnt(23)
  global_load_lds_dwordx4 v35, s[50:51] offset:1024 nt
  s_waitcnt vmcnt(23)
  global_load_lds_dwordx4 v36, s[50:51] offset:2048 nt
  s_waitcnt vmcnt(23)
  global_load_lds_dwordx4 v37, s[50:51] offset:3072 nt
  s_waitcnt vmcnt(23)
  s_mov_b32 m0, 69632
  s_add_u32 s50, s50, 32768
  s_addc_u32 s51, s51, 0
  global_load_lds_dwordx4 v34, s[50:51] offset:0 nt
  s_waitcnt vmcnt(23)
  global_load_lds_dwordx4 v35, s[50:51] offset:1024 nt
  s_waitcnt vmcnt(23)
  global_load_lds_dwordx4 v36, s[50:51] offset:2048 nt
  s_waitcnt vmcnt(23)
  s_mov_b64 exec, 1
  ds_add_u32 v15, v16 offset:20
  s_mov_b64 exec, -1
  global_load_lds_dwordx4 v37, s[50:51] offset:3072 nt
  s_waitcnt vmcnt(23)
  s_mov_b32 m0, 73728
  s_add_u32 s50, s50, 32768
  s_addc_u32 s51, s51, 0
  global_load_lds_dwordx4 v34, s[50:51] offset:0 nt
  s_waitcnt vmcnt(23)
  global_load_lds_dwordx4 v35, s[50:51] offset:1024 nt
  s_waitcnt vmcnt(23)
  global_load_lds_dwordx4 v36, s[50:51] offset:2048 nt
  s_waitcnt vmcnt(23)
  global_load_lds_dwordx4 v37, s[50:51] offset:3072 nt
  s_waitcnt vmcnt(23)
  s_mov_b32 m0, 77824
  s_add_u32 s50, s50, 32768
  s_addc_u32 s51, s51, 0
  global_load_lds_dwordx4 v34, s[50:51] offset:0 nt
  s_waitcnt vmcnt(23)
  global_load_lds_dwordx4 v35, s[50:51] offset:1024 nt
  s_waitcnt vmcnt(23)
  global_load_lds_dwordx4 v36, s[50:51] offset:2048 nt
  s_waitcnt vmcnt(23)
  s_mov_b64 exec, 1
  ds_add_u32 v15, v16 offset:20
  s_mov_b64 exec, -1
  global_load_lds_dwordx4 v37, s[50:51] offset:3072 nt
  s_branch L_FIN
L_LN2:
  s_load_dword s32, s[30:31], 0
  s_mov_b32 s62, 0xffff0000
  v_mul_u32_u24 v5, 1088, v1
  v_lshl_add_u32 v5, v2, 4, v5
  v_add_u32 v5, 122880, v5
  s_lshl_b32 s56, s4, 2
  s_add_u32 s56, s56, s38
  s_lshl_b32 s56, s56, 5
  s_add_u32 s56, s56, s39
  s_lshl_b32 s56, s56, 9
  s_add_u32 s56, s56, 724992
  v_lshrrev_b32 v6, 2, v2
  v_lshlrev_b32 v6, 12, v6
  v_and_b32 v4, 3, v0
  v_lshl_add_u32 v6, v4, 7, v6
  v_add_u32 v6, s56, v6
  s_lshr_b32 s56, s5, 1
  s_lshl_b32 s56, s56, 3
  s_add_u32 s56, s56, s4
  s_and_b32 s57, s56, 1
  s_lshr_b32 s56, s56, 1
  s_lshl2_add_u32 s56, s56, s57
  s_lshr_b32 s57, s4, 2
  s_xor_b32 s57, s57, 0
  s_mov_b32 s57, 0
  s_lshl1_add_u32 s56, s57, s56
  s_lshl_b32 s56, s56, 1
  s_and_b32 s57, s5, 1
  s_add_u32 s56, s56, s57
  s_lshl_b32 s56, s56, 11
  s_add_u32 s56, s56, 2621440
  v_lshl_add_u32 v4, v2, 7, s56
  v_cmp_gt_u32 vcc, 16, v0
  v_mov_b32 v3, 128256
  v_mov_b32 v7, 1
  v_cndmask_b32 v6, v4, v6, vcc
  s_waitcnt vmcnt(1) lgkmcnt(0)
  v_lshlrev_b32 v36, 16, v20
  v_and_b32 v37, s62, v20
  v_lshlrev_b32 v38, 16, v21
  v_and_b32 v39, s62, v21
  v_lshlrev_b32 v40, 16, v22
  v_and_b32 v41, s62, v22
  v_lshlrev_b32 v42, 16, v23
  v_and_b32 v43, s62, v23
  v_lshlrev_b32 v44, 16, v24
  v_and_b32 v45, s62, v24
  v_lshlrev_b32 v46, 16, v25
  v_and_b32 v47, s62, v25
  v_lshlrev_b32 v48, 16, v26
  v_and_b32 v49, s62, v26
  v_lshlrev_b32 v50, 16, v27
  v_and_b32 v51, s62, v27
  v_lshlrev_b32 v52, 16, v28
  v_and_b32 v53, s62, v28
  v_lshlrev_b32 v54, 16, v29
  v_and_b32 v55, s62, v29
  v_lshlrev_b32 v56, 16, v30
  v_and_b32 v57, s62, v30
  v_lshlrev_b32 v58, 16, v31
  v_and_b32 v59, s62, v31
  v_lshlrev_b32 v60, 16, v32
  v_and_b32 v61, s62, v32
  v_lshlrev_b32 v62, 16, v33
  v_and_b32 v63, s62, v33
  v_lshlrev_b32 v64, 16, v34
  v_and_b32 v65, s62, v34
  v_lshlrev_b32 v66, 16, v35
  v_and_b32 v67, s62, v35
  v_pk_add_f32 v[8:9], v[36:37], v[38:39]
  v_pk_add_f32 v[10:11], v[40:41], v[42:43]
  v_pk_add_f32 v[8:9], v[8:9], v[44:45]
  v_pk_add_f32 v[10:11], v[10:11], v[46:47]
  v_pk_add_f32 v[8:9], v[8:9], v[48:49]
  v_pk_add_f32 v[10:11], v[10:11], v[50:51]
  v_pk_add_f32 v[8:9], v[8:9], v[52:53]
  v_pk_add_f32 v[10:11], v[10:11], v[54:55]
  v_pk_add_f32 v[8:9], v[8:9], v[56:57]
  v_pk_add_f32 v[10:11], v[10:11], v[58:59]
  v_pk_add_f32 v[8:9], v[8:9], v[60:61]
  v_pk_add_f32 v[10:11], v[10:11], v[62:63]
  v_pk_add_f32 v[8:9], v[8:9], v[64:65]
  v_pk_add_f32 v[10:11], v[10:11], v[66:67]
  v_pk_add_f32 v[8:9], v[8:9], v[10:11]
  v_add_f32 v12, v8, v9
  s_nop 1
  v_add_f32_dpp v12, v12, v12 row_ror:1 row_mask:0xf bank_mask:0xf
  s_nop 1
  v_add_f32_dpp v12, v12, v12 row_ror:2 row_mask:0xf bank_mask:0xf
  s_nop 1
  v_add_f32_dpp v12, v12, v12 row_ror:4 row_mask:0xf bank_mask:0xf
  s_nop 1
  v_add_f32_dpp v12, v12, v12 row_ror:8 row_mask:0xf bank_mask:0xf
  v_mul_f32 v12, 0x3b000000, v12
  v_pk_add_f32 v[68:69], v[36:37], v[12:13] op_sel_hi:[1,0] neg_lo:[0,1] neg_hi:[0,1]
  v_pk_add_f32 v[70:71], v[38:39], v[12:13] op_sel_hi:[1,0] neg_lo:[0,1] neg_hi:[0,1]
  v_pk_add_f32 v[72:73], v[40:41], v[12:13] op_sel_hi:[1,0] neg_lo:[0,1] neg_hi:[0,1]
  v_pk_add_f32 v[74:75], v[42:43], v[12:13] op_sel_hi:[1,0] neg_lo:[0,1] neg_hi:[0,1]
  v_pk_add_f32 v[76:77], v[44:45], v[12:13] op_sel_hi:[1,0] neg_lo:[0,1] neg_hi:[0,1]
  v_pk_add_f32 v[78:79], v[46:47], v[12:13] op_sel_hi:[1,0] neg_lo:[0,1] neg_hi:[0,1]
  v_pk_add_f32 v[80:81], v[48:49], v[12:13] op_sel_hi:[1,0] neg_lo:[0,1] neg_hi:[0,1]
  v_pk_add_f32 v[82:83], v[50:51], v[12:13] op_sel_hi:[1,0] neg_lo:[0,1] neg_hi:[0,1]
  v_pk_add_f32 v[84:85], v[52:53], v[12:13] op_sel_hi:[1,0] neg_lo:[0,1] neg_hi:[0,1]
  v_pk_add_f32 v[86:87], v[54:55], v[12:13] op_sel_hi:[1,0] neg_lo:[0,1] neg_hi:[0,1]
  v_pk_add_f32 v[88:89], v[56:57], v[12:13] op_sel_hi:[1,0] neg_lo:[0,1] neg_hi:[0,1]
  v_pk_add_f32 v[90:91], v[58:59], v[12:13] op_sel_hi:[1,0] neg_lo:[0,1] neg_hi:[0,1]
  v_pk_add_f32 v[92:93], v[60:61], v[12:13] op_sel_hi:[1,0] neg_lo:[0,1] neg_hi:[0,1]
  v_pk_add_f32 v[94:95], v[62:63], v[12:13] op_sel_hi:[1,0] neg_lo:[0,1] neg_hi:[0,1]
  v_pk_add_f32 v[96:97], v[64:65], v[12:13] op_sel_hi:[1,0] neg_lo:[0,1] neg_hi:[0,1]
  v_pk_add_f32 v[98:99], v[66:67], v[12:13] op_sel_hi:[1,0] neg_lo:[0,1] neg_hi:[0,1]
  v_pk_mul_f32 v[8:9], v[68:69], v[68:69]
  v_pk_mul_f32 v[10:11], v[70:71], v[70:71]
  v_pk_fma_f32 v[8:9], v[72:73], v[72:73], v[8:9]
  v_pk_fma_f32 v[10:11], v[74:75], v[74:75], v[10:11]
  v_pk_fma_f32 v[8:9], v[76:77], v[76:77], v[8:9]
  v_pk_fma_f32 v[10:11], v[78:79], v[78:79], v[10:11]
  v_pk_fma_f32 v[8:9], v[80:81], v[80:81], v[8:9]
  v_pk_fma_f32 v[10:11], v[82:83], v[82:83], v[10:11]
  v_pk_fma_f32 v[8:9], v[84:85], v[84:85], v[8:9]
  v_pk_fma_f32 v[10:11], v[86:87], v[86:87], v[10:11]
  v_pk_fma_f32 v[8:9], v[88:89], v[88:89], v[8:9]
  v_pk_fma_f32 v[10:11], v[90:91], v[90:91], v[10:11]
  v_pk_fma_f32 v[8:9], v[92:93], v[92:93], v[8:9]
  v_pk_fma_f32 v[10:11], v[94:95], v[94:95], v[10:11]
  v_pk_fma_f32 v[8:9], v[96:97], v[96:97], v[8:9]
  v_pk_fma_f32 v[10:11], v[98:99], v[98:99], v[10:11]
  v_pk_add_f32 v[8:9], v[8:9], v[10:11]
  v_add_f32 v14, v8, v9
  s_nop 1
  v_add_f32_dpp v14, v14, v14 row_ror:1 row_mask:0xf bank_mask:0xf
  s_nop 1
  v_add_f32_dpp v14, v14, v14 row_ror:2 row_mask:0xf bank_mask:0xf
  s_nop 1
  v_add_f32_dpp v14, v14, v14 row_ror:4 row_mask:0xf bank_mask:0xf
  s_nop 1
  v_add_f32_dpp v14, v14, v14 row_ror:8 row_mask:0xf bank_mask:0xf
  v_mul_f32 v14, 0x3b000000, v14
  v_cvt_pk_bf16_f32 v12, v12, v14
  v_and_b32 v14, s62, v12
  v_lshlrev_b32 v12, 16, v12
  v_add_f32 v14, 0x3727c5ac, v14
  v_cvt_pk_bf16_f32 v14, v14, v14
  v_and_b32 v14, s62, v14
  v_sqrt_f32 v14, v14
  s_nop 0
  v_cvt_pk_bf16_f32 v14, v14, v14
  v_and_b32 v14, s62, v14
  v_rcp_f32 v14, v14
  s_nop 0
  v_mul_f32 v12, v12, v14
  v_pk_fma_f32 v[68:69], v[36:37], v[14:15], v[12:13] op_sel_hi:[1,0,0] neg_lo:[0,0,1] neg_hi:[0,0,1]
  v_cvt_pk_bf16_f32 v20, v68, v69
  v_pk_fma_f32 v[70:71], v[38:39], v[14:15], v[12:13] op_sel_hi:[1,0,0] neg_lo:[0,0,1] neg_hi:[0,0,1]
  v_cvt_pk_bf16_f32 v21, v70, v71
  v_pk_fma_f32 v[72:73], v[40:41], v[14:15], v[12:13] op_sel_hi:[1,0,0] neg_lo:[0,0,1] neg_hi:[0,0,1]
  v_cvt_pk_bf16_f32 v22, v72, v73
  v_pk_fma_f32 v[74:75], v[42:43], v[14:15], v[12:13] op_sel_hi:[1,0,0] neg_lo:[0,0,1] neg_hi:[0,0,1]
  v_cvt_pk_bf16_f32 v23, v74, v75
  ds_write_b128 v5, v[20:23] offset:0
  v_pk_fma_f32 v[76:77], v[44:45], v[14:15], v[12:13] op_sel_hi:[1,0,0] neg_lo:[0,0,1] neg_hi:[0,0,1]
  v_cvt_pk_bf16_f32 v24, v76, v77
  v_pk_fma_f32 v[78:79], v[46:47], v[14:15], v[12:13] op_sel_hi:[1,0,0] neg_lo:[0,0,1] neg_hi:[0,0,1]
  v_cvt_pk_bf16_f32 v25, v78, v79
  v_pk_fma_f32 v[80:81], v[48:49], v[14:15], v[12:13] op_sel_hi:[1,0,0] neg_lo:[0,0,1] neg_hi:[0,0,1]
  v_cvt_pk_bf16_f32 v26, v80, v81
  v_pk_fma_f32 v[82:83], v[50:51], v[14:15], v[12:13] op_sel_hi:[1,0,0] neg_lo:[0,0,1] neg_hi:[0,0,1]
  v_cvt_pk_bf16_f32 v27, v82, v83
  ds_write_b128 v5, v[24:27] offset:256
  v_pk_fma_f32 v[84:85], v[52:53], v[14:15], v[12:13] op_sel_hi:[1,0,0] neg_lo:[0,0,1] neg_hi:[0,0,1]
  v_cvt_pk_bf16_f32 v28, v84, v85
  v_pk_fma_f32 v[86:87], v[54:55], v[14:15], v[12:13] op_sel_hi:[1,0,0] neg_lo:[0,0,1] neg_hi:[0,0,1]
  v_cvt_pk_bf16_f32 v29, v86, v87
  v_pk_fma_f32 v[88:89], v[56:57], v[14:15], v[12:13] op_sel_hi:[1,0,0] neg_lo:[0,0,1] neg_hi:[0,0,1]
  v_cvt_pk_bf16_f32 v30, v88, v89
  v_pk_fma_f32 v[90:91], v[58:59], v[14:15], v[12:13] op_sel_hi:[1,0,0] neg_lo:[0,0,1] neg_hi:[0,0,1]
  v_cvt_pk_bf16_f32 v31, v90, v91
  ds_write_b128 v5, v[28:31] offset:512
  v_pk_fma_f32 v[92:93], v[60:61], v[14:15], v[12:13] op_sel_hi:[1,0,0] neg_lo:[0,0,1] neg_hi:[0,0,1]
  v_cvt_pk_bf16_f32 v32, v92, v93
  v_pk_fma_f32 v[94:95], v[62:63], v[14:15], v[12:13] op_sel_hi:[1,0,0] neg_lo:[0,0,1] neg_hi:[0,0,1]
  v_cvt_pk_bf16_f32 v33, v94, v95
  v_pk_fma_f32 v[96:97], v[64:65], v[14:15], v[12:13] op_sel_hi:[1,0,0] neg_lo:[0,0,1] neg_hi:[0,0,1]
  v_cvt_pk_bf16_f32 v34, v96, v97
  v_pk_fma_f32 v[98:99], v[66:67], v[14:15], v[12:13] op_sel_hi:[1,0,0] neg_lo:[0,0,1] neg_hi:[0,0,1]
  v_cvt_pk_bf16_f32 v35, v98, v99
  ds_write_b128 v5, v[32:35] offset:768
  s_mov_b64 exec, 1
  ds_add_u32 v3, v7
  s_mov_b32 exec_lo, -1
  s_mov_b64 exec, -1
  s_setprio 1
  s_lshl_b32 s56, s41, 8
  s_and_b32 s57, s38, 1
  s_lshl_b32 s57, s57, 7
  s_cmp_eq_u32 s63, 0
  s_cselect_b32 s57, s57, 0
  s_cselect_b32 s58, 7, 15
  s_add_u32 s56, s56, s57
  s_add_u32 s56, s56, 266240
  s_add_u32 s57, s63, 3
  v_lshrrev_b32 v8, s57, v0
  v_mul_u32_u24 v8, 7168, v8
  v_and_b32 v9, s58, v0
  v_lshl_add_u32 v8, v9, 4, v8
  v_add_u32 v8, s56, v8
  v_lshl_add_u32 v9, v2, 2, v1
  v_lshlrev_b32 v9, 1, v9
  v_add_u32 v9, 132224, v9
  s_mov_b32 s40, 0x40000
  s_mov_b32 s65, 24
  s_waitcnt lgkmcnt(0)
  s_add_u32 s32, s32, 0x9e3779b1
  s_and_b32 s33, s32, 0xff
  s_bfe_u32 s34, s32, 0x80008
  s_bfe_u32 s35, s32, 0x80010
  s_lshr_b32 s36, s32, 24
  s_getreg_b32 s37, hwreg(HW_REG_XCC_ID)
  s_bfe_u32 s37, s37, 0x10002
L_hw:
  ds_read_b32 v10, v3 offset:8
  s_sub_u32 s40, s40, 1
  s_cbranch_scc1 L_end
  s_sleep 1
  s_waitcnt lgkmcnt(0)
  v_readfirstlane_b32 s56, v10
  s_cmp_lt_u32 s56, 1
  s_cbranch_scc1 L_hw
  s_mov_b32 s40, 0x40000
  s_mov_b64 exec, 0xffff
  global_load_dword v17, v6, s[30:31]
  s_mov_b64 exec, -1
L_hpoll:
  v_add_u32 v10, 0, v8
  global_load_dwordx4 v[36:39], v10, s[30:31] sc1
  v_add_u32 v10, 229376, v8
  global_load_dwordx4 v[52:55], v10, s[30:31] sc1
  v_add_u32 v10, 57344, v8
  global_load_dwordx4 v[40:43], v10, s[30:31] sc1
  v_add_u32 v10, 286720, v8
  global_load_dwordx4 v[56:59], v10, s[30:31] sc1
  v_add_u32 v10, 114688, v8
  global_load_dwordx4 v[44:47], v10, s[30:31] sc1
  v_add_u32 v10, 344064, v8
  global_load_dwordx4 v[60:63], v10, s[30:31] sc1
  v_add_u32 v10, 172032, v8
  global_load_dwordx4 v[48:51], v10, s[30:31] sc1
  v_add_u32 v10, 401408, v8
  global_load_dwordx4 v[64:67], v10, s[30:31] sc1
  s_cmp_eq_u32 s40, 0x40000
  s_cbranch_scc0 L_nohint
  s_sleep 18
  s_load_dword s66, s[30:31], 128
  s_waitcnt lgkmcnt(0)
  s_xor_b32 s56, s66, s32
  s_xor_b32 s57, s66, s37
  s_and_b32 s57, s57, 1
  s_lshl_b32 s57, s57, 13
  s_cmp_lt_u32 s56, 2
  s_cselect_b32 s57, s57, 0
  v_mov_b32 v19, s57
  v_add_u32 v6, s57, v6
  ds_write_b32 v3, v19 offset:32
  s_mov_b32 exec_lo, 0xffff0000
  s_mov_b32 exec_hi, 0
  global_load_dword v18, v6, s[30:31]
  s_mov_b64 exec, -1
  s_sub_u32 s40, s40, 1
  s_waitcnt vmcnt(1)
  s_branch L_hchk
L_nohint:
  s_sub_u32 s40, s40, 1
  s_cbranch_scc1 L_end
  s_sub_u32 s65, s65, 1
  s_cmp_le_i32 s65, 0
  s_cselect_b32 s56, 4194304, 0
  v_xor_b32 v8, s56, v8
  s_waitcnt vmcnt(0)
L_hchk:
  v_xor_b32 v36, s33, v36
  v_xor_b32 v37, s34, v37
  v_xor_b32 v38, s35, v38
  v_xor_b32 v39, s36, v39
  v_xor_b32 v40, s33, v40
  v_xor_b32 v41, s34, v41
  v_xor_b32 v42, s35, v42
  v_xor_b32 v43, s36, v43
  v_xor_b32 v44, s33, v44
  v_xor_b32 v45, s34, v45
  v_xor_b32 v46, s35, v46
  v_xor_b32 v47, s36, v47
  v_xor_b32 v48, s33, v48
  v_xor_b32 v49, s34, v49
  v_xor_b32 v50, s35, v50
  v_xor_b32 v51, s36, v51
  v_xor_b32 v52, s33, v52
  v_xor_b32 v53, s34, v53
  v_xor_b32 v54, s35, v54
  v_xor_b32 v55, s36, v55
  v_xor_b32 v56, s33, v56
  v_xor_b32 v57, s34, v57
  v_xor_b32 v58, s35, v58
  v_xor_b32 v59, s36, v59
  v_xor_b32 v60, s33, v60
  v_xor_b32 v61, s34, v61
  v_xor_b32 v62, s35, v62
  v_xor_b32 v63, s36, v63
  v_xor_b32 v64, s33, v64
  v_xor_b32 v65, s34, v65
  v_xor_b32 v66, s35, v66
  v_xor_b32 v67, s36, v67
  v_or3_b32 v10, v36, v37, v38
  v_or3_b32 v10, v10, v39, v40
  v_or3_b32 v10, v10, v41, v42
  v_or3_b32 v10, v10, v43, v44
  v_or3_b32 v10, v10, v45, v46
  v_or3_b32 v10, v10, v47, v48
  v_or3_b32 v10, v10, v49, v50
  v_or3_b32 v10, v10, v51, v52
  v_or3_b32 v10, v10, v53, v54
  v_or3_b32 v10, v10, v55, v56
  v_or3_b32 v10, v10, v57, v58
  v_or3_b32 v10, v10, v59, v60
  v_or3_b32 v10, v10, v61, v62
  v_or3_b32 v10, v10, v63, v64
  v_or3_b32 v10, v10, v65, v66
  v_or_b32 v10, v10, v67
  v_and_b32 v10, 0xff, v10
  v_cmp_ne_u32 vcc, 0, v10
  s_cbranch_vccnz L_hpoll
  s_mov_b64 vcc, -1
  s_cmp_eq_u32 s63, 0
  s_cbranch_scc0 L_hfull
  v_add_f32_dpp v36, v36, v36 row_ror:8 row_mask:0xf bank_mask:0xf
  v_add_f32_dpp v37, v37, v37 row_ror:8 row_mask:0xf bank_mask:0xf
  v_add_f32_dpp v38, v38, v38 row_ror:8 row_mask:0xf bank_mask:0xf
  v_add_f32_dpp v39, v39, v39 row_ror:8 row_mask:0xf bank_mask:0xf
  v_add_f32_dpp v40, v40, v40 row_ror:8 row_mask:0xf bank_mask:0xf
  v_add_f32_dpp v41, v41, v41 row_ror:8 row_mask:0xf bank_mask:0xf
  v_add_f32_dpp v42, v42, v42 row_ror:8 row_mask:0xf bank_mask:0xf
  v_add_f32_dpp v43, v43, v43 row_ror:8 row_mask:0xf bank_mask:0xf
  v_add_f32_dpp v44, v44, v44 row_ror:8 row_mask:0xf bank_mask:0xf
  v_add_f32_dpp v45, v45, v45 row_ror:8 row_mask:0xf bank_mask:0xf
  v_add_f32_dpp v46, v46, v46 row_ror:8 row_mask:0xf bank_mask:0xf
  v_add_f32_dpp v47, v47, v47 row_ror:8 row_mask:0xf bank_mask:0xf
  v_add_f32_dpp v48, v48, v48 row_ror:8 row_mask:0xf bank_mask:0xf
  v_add_f32_dpp v49, v49, v49 row_ror:8 row_mask:0xf bank_mask:0xf
  v_add_f32_dpp v50, v50, v50 row_ror:8 row_mask:0xf bank_mask:0xf
  v_add_f32_dpp v51, v51, v51 row_ror:8 row_mask:0xf bank_mask:0xf
  v_add_f32_dpp v52, v52, v52 row_ror:8 row_mask:0xf bank_mask:0xf
  v_add_f32_dpp v53, v53, v53 row_ror:8 row_mask:0xf bank_mask:0xf
  v_add_f32_dpp v54, v54, v54 row_ror:8 row_mask:0xf bank_mask:0xf
  v_add_f32_dpp v55, v55, v55 row_ror:8 row_mask:0xf bank_mask:0xf
  v_add_f32_dpp v56, v56, v56 row_ror:8 row_mask:0xf bank_mask:0xf
  v_add_f32_dpp v57, v57, v57 row_ror:8 row_mask:0xf bank_mask:0xf
  v_add_f32_dpp v58, v58, v58 row_ror:8 row_mask:0xf bank_mask:0xf
  v_add_f32_dpp v59, v59, v59 row_ror:8 row_mask:0xf bank_mask:0xf
  v_add_f32_dpp v60, v60, v60 row_ror:8 row_mask:0xf bank_mask:0xf
  v_add_f32_dpp v61, v61, v61 row_ror:8 row_mask:0xf bank_mask:0xf
  v_add_f32_dpp v62, v62, v62 row_ror:8 row_mask:0xf bank_mask:0xf
  v_add_f32_dpp v63, v63, v63 row_ror:8 row_mask:0xf bank_mask:0xf
  v_add_f32_dpp v64, v64, v64 row_ror:8 row_mask:0xf bank_mask:0xf
  v_add_f32_dpp v65, v65, v65 row_ror:8 row_mask:0xf bank_mask:0xf
  v_add_f32_dpp v66, v66, v66 row_ror:8 row_mask:0xf bank_mask:0xf
  v_add_f32_dpp v67, v67, v67 row_ror:8 row_mask:0xf bank_mask:0xf
  s_mov_b32 vcc_lo, 0x00ff00ff
  s_mov_b32 vcc_hi, 0x00ff00ff
L_hfull:
  v_permlane16_swap_b32 v36, v37
  v_permlane16_swap_b32 v38, v39
  v_permlane16_swap_b32 v52, v53
  v_permlane16_swap_b32 v54, v55
  v_add_f32 v36, v36, v37
  v_add_f32 v38, v38, v39
  v_add_f32 v52, v52, v53
  v_add_f32 v54, v54, v55
  v_permlane32_swap_b32 v36, v38
  s_nop 0
  v_permlane32_swap_b32 v52, v54
  v_add_f32 v36, v36, v38
  v_add_f32 v52, v52, v54
  v_cvt_pk_bf16_f32 v36, v36, v36
  v_and_b32 v36, s62, v36
  v_cvt_pk_bf16_f32 v52, v52, v52
  v_and_b32 v52, s62, v52
  v_mul_f32 v12, 0xbfb8aa3b, v36
  v_exp_f32 v12, v12
  s_nop 0
  v_add_f32 v12, 1.0, v12
  v_rcp_f32 v12, v12
  s_nop 0
  v_mul_f32 v12, v12, v36
  v_cvt_pk_bf16_f32 v12, v12, v12
  v_and_b32 v12, s62, v12
  v_mul_f32 v12, v12, v52
  v_cvt_pk_bf16_f32 v12, v12, v12
  v_cndmask_b32 v12, 0, v12, vcc
  v_permlane16_swap_b32 v40, v41
  v_permlane16_swap_b32 v42, v43
  v_permlane16_swap_b32 v56, v57
  v_permlane16_swap_b32 v58, v59
  v_add_f32 v40, v40, v41
  v_add_f32 v42, v42, v43
  v_add_f32 v56, v56, v57
  v_add_f32 v58, v58, v59
  v_permlane32_swap_b32 v40, v42
  s_nop 0
  v_permlane32_swap_b32 v56, v58
  v_add_f32 v40, v40, v42
  v_add_f32 v56, v56, v58
  v_cvt_pk_bf16_f32 v40, v40, v40
  v_and_b32 v40, s62, v40
  v_cvt_pk_bf16_f32 v56, v56, v56
  v_and_b32 v56, s62, v56
  v_mul_f32 v13, 0xbfb8aa3b, v40
  v_exp_f32 v13, v13
  s_nop 0
  v_add_f32 v13, 1.0, v13
  v_rcp_f32 v13, v13
  s_nop 0
  v_mul_f32 v13, v13, v40
  v_cvt_pk_bf16_f32 v13, v13, v13
  v_and_b32 v13, s62, v13
  v_mul_f32 v13, v13, v56
  v_cvt_pk_bf16_f32 v13, v13, v13
  v_cndmask_b32 v13, 0, v13, vcc
  v_permlane16_swap_b32 v44, v45
  v_permlane16_swap_b32 v46, v47
  v_permlane16_swap_b32 v60, v61
  v_permlane16_swap_b32 v62, v63
  v_add_f32 v44, v44, v45
  v_add_f32 v46, v46, v47
  v_add_f32 v60, v60, v61
  v_add_f32 v62, v62, v63
  v_permlane32_swap_b32 v44, v46
  s_nop 0
  v_permlane32_swap_b32 v60, v62
  v_add_f32 v44, v44, v46
  v_add_f32 v60, v60, v62
  v_cvt_pk_bf16_f32 v44, v44, v44
  v_and_b32 v44, s62, v44
  v_cvt_pk_bf16_f32 v60, v60, v60
  v_and_b32 v60, s62, v60
  v_mul_f32 v14, 0xbfb8aa3b, v44
  v_exp_f32 v14, v14
  s_nop 0
  v_add_f32 v14, 1.0, v14
  v_rcp_f32 v14, v14
  s_nop 0
  v_mul_f32 v14, v14, v44
  v_cvt_pk_bf16_f32 v14, v14, v14
  v_and_b32 v14, s62, v14
  v_mul_f32 v14, v14, v60
  v_cvt_pk_bf16_f32 v14, v14, v14
  v_cndmask_b32 v14, 0, v14, vcc
  v_permlane16_swap_b32 v48, v49
  v_permlane16_swap_b32 v50, v51
  v_permlane16_swap_b32 v64, v65
  v_permlane16_swap_b32 v66, v67
  v_add_f32 v48, v48, v49
  v_add_f32 v50, v50, v51
  v_add_f32 v64, v64, v65
  v_add_f32 v66, v66, v67
  v_permlane32_swap_b32 v48, v50
  s_nop 0
  v_permlane32_swap_b32 v64, v66
  v_add_f32 v48, v48, v50
  v_add_f32 v64, v64, v66
  v_cvt_pk_bf16_f32 v48, v48, v48
  v_and_b32 v48, s62, v48
  v_cvt_pk_bf16_f32 v64, v64, v64
  v_and_b32 v64, s62, v64
  v_mul_f32 v15, 0xbfb8aa3b, v48
  v_exp_f32 v15, v15
  s_nop 0
  v_add_f32 v15, 1.0, v15
  v_rcp_f32 v15, v15
  s_nop 0
  v_mul_f32 v15, v15, v48
  v_cvt_pk_bf16_f32 v15, v15, v15
  v_and_b32 v15, s62, v15
  v_mul_f32 v15, v15, v64
  v_cvt_pk_bf16_f32 v15, v15, v15
  v_cndmask_b32 v15, 0, v15, vcc
  ds_write_b16 v9, v12 offset:0
  ds_write_b16 v9, v13 offset:192
  ds_write_b16 v9, v14 offset:384
  ds_write_b16 v9, v15 offset:576
  s_mov_b64 exec, 1
  ds_add_u32 v3, v7 offset:24
L_hend:
  s_endpgm
L_Q2:
  v_lshrrev_b32 v6, 2, v2
  v_lshl_add_u32 v6, v1, 3, v6
  v_lshlrev_b32 v18, 7, v6
  v_and_b32 v7, 3, v0
  v_lshl_add_u32 v18, v7, 3, v18
  v_bfe_u32 v6, v0, 3, 2
  v_xor_b32 v6, s37, v6
  v_lshl_add_u32 v18, v6, 5, v18
  v_mul_u32_u24 v6, 1088, v7
  v_lshl_add_u32 v6, v1, 4, v6
  s_lshl_b32 s56, s38, 8
  s_add_u32 s56, s56, 122880
  v_add_u32 v17, s56, v6
  s_lshl_b32 s56, s7, s63
  s_lshl_b32 s56, s56, 7
  s_add_u32 s56, s56, 122880
  v_add_u32 v19, s56, v6
  s_lshl_b32 s56, s4, 4
  s_add_u32 s56, s56, s38
  s_lshl_b32 s56, s56, 3
  s_add_u32 s56, s56, s6
  s_lshl_b32 s56, s56, 2
  s_add_u32 s56, s56, s37
  s_lshl_b32 s56, s56, 6
  s_add_u32 s56, s56, 4096
  v_lshlrev_b32 v33, 13, v7
  v_lshl_add_u32 v33, v1, 4, v33
  v_add_u32 v33, s56, v33
  s_and_b32 s56, s39, 1
  s_lshl_b32 s56, s56, 5
  s_add_u32 s56, s56, s7
  s_mul_i32 s56, s56, 7168
  s_lshl_b32 s58, s41, 8
  s_add_u32 s56, s56, s58
  s_add_u32 s56, s56, 266240
  s_lshl_b32 s58, s37, 6
  s_add_u32 s56, s56, s58
  v_mul_u32_u24 v34, 57344, v7
  v_lshl_add_u32 v34, v1, 4, v34
  v_add_u32 v34, s56, v34
  v_mov_b32 v15, 0xffffff00
  s_mov_b32 s48, 0xf000f
  s_mov_b32 s49, 0xf000f
  s_mov_b32 s50, 0xf000f0
  s_mov_b32 s51, 0xf000f0
  s_mov_b32 s52, 0xf000f00
  s_mov_b32 s53, 0xf000f00
  s_mov_b32 s54, 0xf000f000
  s_mov_b32 s55, 0xf000f000
  s_or_b64 s[44:45], s[48:49], s[50:51]
  s_lshl_b32 s58, s4, 2
  s_add_u32 s58, s58, s38
  v_mov_b32 v12, 128256
  v_mov_b32 v13, 1
  s_mov_b32 s64, 0x200000
  s_mov_b32 s65, 24
  s_mov_b32 s40, 0x40000
  s_lshl_b32 s60, s58, 13
  s_lshl_b32 s61, s37, 9
  s_add_u32 s60, s60, s61
  s_add_u32 s60, s60, 6144
  v_lshrrev_b32 v9, 5, v0
  v_and_b32 v8, 31, v0
  v_lshlrev_b32 v14, 4, v8
  v_lshl_add_u32 v14, v9, 11, v14
  v_add_u32 v14, s60, v14
  s_mul_i32 s60, s37, 320
  s_add_u32 s60, s60, 128320
  v_lshlrev_b32 v28, 3, v8
  v_lshl_add_u32 v28, v9, 2, v28
  v_add_u32 v28, s60, v28
  s_waitcnt lgkmcnt(0)
  s_add_u32 s32, s32, 0x9e3779b1
  s_and_b32 s33, s32, 0xff
  s_bfe_u32 s34, s32, 0x80008
  s_bfe_u32 s35, s32, 0x80010
  s_lshr_b32 s36, s32, 24
  s_getreg_b32 s29, hwreg(HW_REG_XCC_ID, 0, 3)
  s_lshl_b32 s29, s29, 4
  s_xor_b32 s28, s33, s29
  s_waitcnt vmcnt(0)
  s_mov_b64 exec, 1
  ds_add_u32 v12, v13 offset:0
L_sy0:
  ds_read_b32 v6, v12 offset:0
  s_sub_u32 s64, s64, 1
  s_cbranch_scc1 L_end
  s_waitcnt lgkmcnt(0)
  v_readfirstlane_b32 s57, v6
  s_cmp_lt_u32 s57, 5
  s_cbranch_scc1 L_sy0
  s_mov_b64 exec, -1
  ds_read_b128 v[88:91], v17 offset:0
  ds_read_b64_tr_b16 v[116:117], v18 offset:0
  ds_read_b64_tr_b16 v[118:119], v18 offset:512
  ds_read_b128 v[92:95], v17 offset:64
  ds_read_b64_tr_b16 v[120:121], v18 offset:4096
  ds_read_b64_tr_b16 v[122:123], v18 offset:4608
  ds_read_b128 v[96:99], v17 offset:128
  ds_read_b64_tr_b16 v[124:125], v18 offset:8192
  ds_read_b64_tr_b16 v[126:127], v18 offset:8704
  ds_read_b128 v[100:103], v17 offset:192
  ds_read_b64_tr_b16 v[128:129], v18 offset:12288
  ds_read_b64_tr_b16 v[130:131], v18 offset:12800
  s_waitcnt lgkmcnt(9)
  v_mfma_f32_16x16x32_bf16 v[200:203], v[116:119], v[88:91], 0
  s_waitcnt lgkmcnt(6)
  v_mfma_f32_16x16x32_bf16 v[200:203], v[120:123], v[92:95], v[200:203]
  s_waitcnt lgkmcnt(3)
  v_mfma_f32_16x16x32_bf16 v[200:203], v[124:127], v[96:99], v[200:203]
  s_waitcnt lgkmcnt(0)
  v_mfma_f32_16x16x32_bf16 v[200:203], v[128:131], v[100:103], v[200:203]
  s_mov_b64 exec, s[48:49]
  s_nop 6
  v_and_or_b32 v200, v200, v15, s28
  v_and_or_b32 v201, v201, v15, s34
  v_and_or_b32 v202, v202, v15, s35
  v_and_or_b32 v203, v203, v15, s36
  global_store_dwordx4 v33, v[200:203], s[30:31]
  s_mov_b64 exec, -1
  s_nop 0
  v_xor_b32 v200, s29, v200
  s_lshl_b32 s56, s4, 2
  s_add_u32 s56, s56, s37
  s_lshl_b32 s56, s56, 2
  s_add_u32 s56, s56, s38
  s_lshl_b32 s56, s56, 12
  s_add_u32 s56, s56, 724992
  v_lshlrev_b32 v36, 4, v8
  v_lshl_add_u32 v36, v9, 11, v36
  v_add_u32 v36, s56, v36
  s_mov_b64 exec, 1
L_sy1:
  ds_read_b32 v6, v12 offset:4
  s_sub_u32 s64, s64, 1
  s_cbranch_scc1 L_end
  s_waitcnt lgkmcnt(0)
  v_readfirstlane_b32 s57, v6
  s_cmp_lt_u32 s57, 1
  s_cbranch_scc1 L_sy1
  s_mov_b64 exec, -1
  ds_read_b128 v[88:91], v19 offset:0
  ds_read_b64_tr_b16 v[116:117], v18 offset:16384
  ds_read_b64_tr_b16 v[118:119], v18 offset:16896
  ds_read_b128 v[92:95], v19 offset:64
  ds_read_b64_tr_b16 v[120:121], v18 offset:20480
  ds_read_b64_tr_b16 v[122:123], v18 offset:20992
  ds_read_b128 v[96:99], v19 offset:128
  ds_read_b64_tr_b16 v[124:125], v18 offset:24576
  ds_read_b64_tr_b16 v[126:127], v18 offset:25088
  ds_read_b128 v[100:103], v19 offset:192
  ds_read_b64_tr_b16 v[128:129], v18 offset:28672
  ds_read_b64_tr_b16 v[130:131], v18 offset:29184
  s_cmp_eq_u32 s63, 0
  s_waitcnt lgkmcnt(9)
  v_mfma_f32_16x16x32_bf16 v[204:207], v[116:119], v[88:91], 0
  s_waitcnt lgkmcnt(6)
  v_mfma_f32_16x16x32_bf16 v[204:207], v[120:123], v[92:95], v[204:207]
  s_cbranch_scc1 L_phalf
  s_waitcnt lgkmcnt(3)
  v_mfma_f32_16x16x32_bf16 v[204:207], v[124:127], v[96:99], v[204:207]
  s_waitcnt lgkmcnt(0)
  v_mfma_f32_16x16x32_bf16 v[204:207], v[128:131], v[100:103], v[204:207]
L_phalf:
  s_mov_b64 exec, s[48:49]
  s_nop 6
  v_and_or_b32 v204, v204, v15, s33
  v_and_or_b32 v205, v205, v15, s34
  v_and_or_b32 v206, v206, v15, s35
  v_and_or_b32 v207, v207, v15, s36
  global_store_dwordx4 v34, v[204:207], s[30:31]
  s_mov_b64 exec, -1
  global_load_dwordx4 v[80:83], v14, s[30:31] offset:-2048 sc1
  global_load_dwordx4 v[84:87], v14, s[30:31] offset:2048 sc1
  v_add_u32 v18, 65536, v18
  s_lshl_b32 s56, s58, 14
  s_lshl_b32 s60, s39, 9
  s_add_u32 s56, s56, s60
  s_lshl_b32 s60, s37, 7
  s_add_u32 s56, s56, s60
  s_add_u32 s56, s56, 724992
  v_bfe_u32 v8, v0, 2, 2
  v_lshlrev_b32 v35, 12, v7
  v_lshl_add_u32 v35, v8, 6, v35
  v_lshl_add_u32 v35, v1, 4, v35
  v_add_u32 v35, s56, v35
  s_lshl_b32 s56, s37, 13
  s_add_u32 s56, s56, 90112
  v_xor_b32 v6, v1, v2
  v_lshlrev_b32 v6, 4, v6
  v_lshl_add_u32 v6, v2, 8, v6
  v_add_u32 v20, s56, v6
  v_xor_b32 v21, 64, v20
  v_xor_b32 v22, 128, v20
  v_xor_b32 v23, 192, v20
  v_lshrrev_b32 v6, 2, v0
  v_and_b32 v9, 7, v6
  s_lshl_b32 s56, s37, 1
  v_xor_b32 v9, s56, v9
  v_lshlrev_b32 v16, 8, v6
  v_lshl_add_u32 v16, v9, 5, v16
  v_lshl_add_u32 v16, v7, 3, v16
  v_add_u32 v16, 32768, v16
  v_xor_b32 v17, 32, v16
  v_mul_u32_u24 v11, 320, v7
  v_lshl_add_u32 v11, v1, 4, v11
  v_add_u32 v29, 128320, v11
  v_lshlrev_b32 v6, 6, v7
  v_lshl_add_u32 v6, v1, 4, v6
  s_lshl_b32 s56, s37, 8
  s_add_u32 s56, s56, 129600
  v_add_u32 v30, s56, v6
  v_add_u32 v9, 129600, v6
  v_mov_b32 v10, 127232
  v_cndmask_b32 v24, v10, v9, s[48:49]
  v_cndmask_b32 v25, v10, v9, s[50:51]
  v_lshl_add_u32 v9, v7, 7, v6
  v_add_u32 v9, 132224, v9
  v_cndmask_b32 v27, v10, v9, s[50:51]
  v_add_u32 v9, 130944, v11
  v_cndmask_b32 v26, v10, v9, s[48:49]
  v_lshlrev_b32 v32, 4, v7
  v_add_u32 v32, 130624, v32
  s_lshl_b32 s56, s37, 2
  v_add_u32 v31, s56, v32
  s_lshl_b32 s56, s39, 17
  s_and_b32 s60, s37, 2
  s_lshl_b32 s60, s60, 13
  s_add_u32 s56, s56, s60
  s_and_b32 s60, s37, 1
  s_lshl_b32 s60, s60, 12
  s_add_u32 s56, s56, s60
  s_lshl_b32 s60, s58, 7
  s_add_u32 s56, s56, s60
  s_add_u32 s56, s56, 2621440
  v_lshlrev_b32 v37, 15, v7
  v_lshrrev_b32 v9, 5, v0
  v_lshl_add_u32 v37, v9, 6, v37
  v_bfe_u32 v9, v0, 2, 1
  v_lshl_add_u32 v37, v9, 5, v37
  v_bfe_u32 v9, v0, 4, 1
  v_lshl_add_u32 v37, v9, 4, v37
  s_lshr_b32 s60, s4, 2
  v_xor_b32 v9, s60, v0
  v_and_b32 v9, 1, v9
  v_lshl_add_u32 v37, v9, 13, v37
  v_add_u32 v37, s56, v37
  s_mov_b32 s62, 0xffff0000
  s_branch L_Q3
.p2align 12
L_pad0:
  s_sleep 6
  s_setpc_b64 s[90:91]
L_Q3:
  s_sleep 4
  s_sleep 4
  global_load_dwordx4 v[72:75], v14, s[30:31] offset:-2048 sc1
  global_load_dwordx4 v[76:79], v14, s[30:31] offset:2048 sc1
  s_waitcnt vmcnt(2)
  v_xor_b32 v80, s28, v80
  v_xor_b32 v81, s34, v81
  v_xor_b32 v82, s35, v82
  v_xor_b32 v83, s36, v83
  v_xor_b32 v84, s28, v84
  v_xor_b32 v85, s34, v85
  v_xor_b32 v86, s35, v86
  v_xor_b32 v87, s36, v87
  v_or3_b32 v6, v80, v81, v82
  v_or3_b32 v6, v6, v83, v84
  v_or3_b32 v6, v6, v85, v86
  v_or_b32 v6, v6, v87
  v_and_b32 v6, 0xff, v6
  v_cmp_ne_u32 vcc, 0, v6
  s_cbranch_vccnz L_qchk
  v_pk_add_f32 v[104:105], v[80:81], v[84:85]
  v_pk_add_f32 v[106:107], v[82:83], v[86:87]
  s_branch L_qok2
L_qchk:
  s_waitcnt vmcnt(0)
  v_xor_b32 v72, s28, v72
  v_xor_b32 v73, s34, v73
  v_xor_b32 v74, s35, v74
  v_xor_b32 v75, s36, v75
  v_xor_b32 v76, s28, v76
  v_xor_b32 v77, s34, v77
  v_xor_b32 v78, s35, v78
  v_xor_b32 v79, s36, v79
  v_or3_b32 v6, v72, v73, v74
  v_or3_b32 v6, v6, v75, v76
  v_or3_b32 v6, v6, v77, v78
  v_or_b32 v6, v6, v79
  v_and_b32 v6, 0xff, v6
  v_cmp_ne_u32 vcc, 0, v6
  s_cbranch_vccz L_qok
  s_sub_u32 s65, s65, 1
  s_cmp_gt_i32 s65, 0
  s_cbranch_scc0 L_slow0
L_qchkr:
  global_load_dwordx4 v[72:75], v14, s[30:31] offset:-2048 sc1
  global_load_dwordx4 v[76:79], v14, s[30:31] offset:2048 sc1
  s_sub_u32 s40, s40, 1
  s_cbranch_scc0 L_qchk
  s_endpgm
L_pad1:
  s_sleep 6
  s_setpc_b64 s[90:91]
L_qok:
  v_pk_add_f32 v[104:105], v[72:73], v[76:77]
  v_pk_add_f32 v[106:107], v[74:75], v[78:79]
L_qok2:
  s_nop 1
  v_permlane32_swap_b32 v104, v106
  v_permlane32_swap_b32 v105, v107
  v_pk_add_f32 v[104:105], v[104:105], v[106:107]
  v_cvt_pk_bf16_f32 v104, v104, v105
  ds_write_b32 v28, v104
  s_mov_b64 exec, 1
  ds_add_u32 v12, v13 offset:8
L_sy2:
  ds_read_b32 v6, v12 offset:8
  s_sub_u32 s64, s64, 1
  s_cbranch_scc1 L_end
  s_and_b32 s57, s64, 0x3ff
  s_cbranch_scc0 L_slow1
  s_waitcnt lgkmcnt(0)
  v_readfirstlane_b32 s57, v6
  s_cmp_lt_u32 s57, 5
  s_cbranch_scc1 L_sy2
  s_mov_b64 exec, -1
  ds_read_b128 v[88:91], v29 offset:0
  ds_read_b128 v[40:43], v20 offset:0
  ds_read_b128 v[44:47], v20 offset:4096
  ds_read_b128 v[92:95], v29 offset:64
  ds_read_b128 v[48:51], v21 offset:0
  ds_read_b128 v[52:55], v21 offset:4096
  ds_read_b128 v[96:99], v29 offset:128
  ds_read_b128 v[56:59], v22 offset:0
  ds_read_b128 v[60:63], v22 offset:4096
  ds_read_b128 v[100:103], v29 offset:192
  ds_read_b128 v[64:67], v23 offset:0
  ds_read_b128 v[68:71], v23 offset:4096
  s_mov_b32 s56, 0x3e0293ee
  s_waitcnt lgkmcnt(9)
  v_mfma_f32_16x16x32_bf16 v[104:107], v[40:43], v[88:91], 0
  v_mfma_f32_16x16x32_bf16 v[108:111], v[44:47], v[88:91], 0
  s_waitcnt lgkmcnt(6)
  v_mfma_f32_16x16x32_bf16 v[104:107], v[48:51], v[92:95], v[104:107]
  v_mfma_f32_16x16x32_bf16 v[108:111], v[52:55], v[92:95], v[108:111]
  s_waitcnt lgkmcnt(3)
  v_mfma_f32_16x16x32_bf16 v[104:107], v[56:59], v[96:99], v[104:107]
  v_mfma_f32_16x16x32_bf16 v[108:111], v[60:63], v[96:99], v[108:111]
  s_waitcnt lgkmcnt(0)
  v_mfma_f32_16x16x32_bf16 v[104:107], v[64:67], v[100:103], v[104:107]
  v_mfma_f32_16x16x32_bf16 v[108:111], v[68:71], v[100:103], v[108:111]
  s_nop 6
  v_max3_f32 v6, v104, v105, v106
  v_max_f32 v6, v6, v107
  v_max3_f32 v7, v108, v109, v110
  v_max3_f32 v6, v6, v7, v111
  v_mov_b32 v7, v6
  s_nop 1
  v_permlane16_swap_b32 v6, v7
  v_max_f32 v6, v6, v7
  v_mov_b32 v7, v6
  s_nop 1
  v_permlane32_swap_b32 v6, v7
  v_max_f32 v6, v6, v7
  v_mul_f32 v6, s56, v6
  v_fma_f32 v104, v104, s56, -v6
  v_fma_f32 v105, v105, s56, -v6
  v_fma_f32 v106, v106, s56, -v6
  v_fma_f32 v107, v107, s56, -v6
  v_fma_f32 v108, v108, s56, -v6
  v_fma_f32 v109, v109, s56, -v6
  v_fma_f32 v110, v110, s56, -v6
  v_fma_f32 v111, v111, s56, -v6
  v_exp_f32 v104, v104
  v_exp_f32 v105, v105
  v_exp_f32 v106, v106
  v_exp_f32 v107, v107
  v_exp_f32 v108, v108
  v_exp_f32 v109, v109
  v_exp_f32 v110, v110
  v_exp_f32 v111, v111
  v_cvt_pk_bf16_f32 v112, v104, v105
  v_cvt_pk_bf16_f32 v113, v106, v107
  v_cvt_pk_bf16_f32 v114, v108, v109
  v_cvt_pk_bf16_f32 v115, v110, v111
  v_pk_add_f32 v[192:193], v[104:105], v[106:107]
  s_mov_b64 exec, s[48:49]
  ds_write_b128 v30, v[112:115]
  s_mov_b64 exec, -1
  v_pk_add_f32 v[194:195], v[108:109], v[110:111]
  v_pk_add_f32 v[192:193], v[192:193], v[194:195]
  v_add_f32 v8, v192, v193
  v_mov_b32 v9, v8
  s_nop 1
  v_permlane16_swap_b32 v8, v9
  v_add_f32 v8, v8, v9
  v_mov_b32 v9, v8
  s_nop 1
  v_permlane32_swap_b32 v8, v9
  v_add_f32 v8, v8, v9
  s_mov_b64 exec, 15
  ds_write2_b32 v31, v8, v6 offset0:0 offset1:16
  s_mov_b64 exec, 1
  ds_add_u32 v12, v13 offset:16
L_sy4:
  ds_read_b32 v6, v12 offset:16
  s_sub_u32 s64, s64, 1
  s_cbranch_scc1 L_end
  s_waitcnt lgkmcnt(0)
  v_readfirstlane_b32 s57, v6
  s_cmp_lt_u32 s57, 4
  s_cbranch_scc1 L_sy4
  s_mov_b64 exec, -1
  ds_read_b128 v[188:191], v32 offset:64
  ds_read_b128 v[192:195], v32
  ds_read_b32 v6, v12 offset:20
  ds_read_b128 v[148:151], v24 offset:0
  ds_read_b128 v[152:155], v25 offset:0
  ds_read_b128 v[156:159], v24 offset:256
  ds_read_b128 v[160:163], v25 offset:256
  ds_read_b128 v[164:167], v24 offset:512
  ds_read_b128 v[168:171], v25 offset:512
  ds_read_b128 v[172:175], v24 offset:768
  ds_read_b128 v[176:179], v25 offset:768
  s_waitcnt lgkmcnt(8)
  v_readfirstlane_b32 s57, v6
  v_max3_f32 v7, v188, v189, v190
  v_max_f32 v7, v7, v191
  v_sub_f32 v188, v188, v7
  v_sub_f32 v189, v189, v7
  v_sub_f32 v190, v190, v7
  v_sub_f32 v191, v191, v7
  s_cmp_ge_u32 s57, 4
  s_cbranch_scc1 L_pvall
  v_exp_f32 v188, v188
  v_exp_f32 v189, v189
  v_exp_f32 v190, v190
  v_exp_f32 v191, v191
  v_mov_b32 v199, s32
  v_pk_mul_f32 v[192:193], v[192:193], v[188:189]
  v_pk_fma_f32 v[192:193], v[194:195], v[190:191], v[192:193]
  v_add_f32 v192, v192, v193
  v_rcp_f32 v194, v192
  v_log_f32 v193, v192
  s_mov_b32 s65, 24
  v_pk_mul_f32 v[188:189], v[188:189], v[194:195] op_sel_hi:[1,0]
  v_pk_mul_f32 v[190:191], v[190:191], v[194:195] op_sel_hi:[1,0]
  v_add_f32 v198, v7, v193
L_syv0:
  ds_read_b32 v6, v12 offset:20
  ds_read_b64_tr_b16 v[116:117], v16 offset:0
  ds_read_b64_tr_b16 v[118:119], v16 offset:4096
  ds_read_b64_tr_b16 v[120:121], v17 offset:0
  ds_read_b64_tr_b16 v[122:123], v17 offset:4096
  s_sub_u32 s64, s64, 1
  s_cbranch_scc1 L_end
  s_waitcnt lgkmcnt(4)
  v_readfirstlane_b32 s57, v6
  s_cmp_lt_u32 s57, 1
  s_cbranch_scc1 L_syv0
  s_waitcnt lgkmcnt(2)
  v_mfma_f32_16x16x32_bf16 v[104:107], v[116:119], v[148:151], 0
  s_waitcnt lgkmcnt(0)
  v_mfma_f32_16x16x32_bf16 v[104:107], v[120:123], v[152:155], v[104:107]
L_syv1:
  ds_read_b32 v6, v12 offset:20
  ds_read_b64_tr_b16 v[124:125], v16 offset:8192
  ds_read_b64_tr_b16 v[126:127], v16 offset:12288
  ds_read_b64_tr_b16 v[128:129], v17 offset:8192
  ds_read_b64_tr_b16 v[130:131], v17 offset:12288
  s_sub_u32 s64, s64, 1
  s_cbranch_scc1 L_end
  s_waitcnt lgkmcnt(4)
  v_readfirstlane_b32 s57, v6
  s_cmp_lt_u32 s57, 2
  s_cbranch_scc1 L_syv1
  v_pk_mul_f32 v[184:185], v[104:105], v[188:189] op_sel:[0,0] op_sel_hi:[1,0]
  v_pk_mul_f32 v[186:187], v[106:107], v[188:189] op_sel:[0,0] op_sel_hi:[1,0]
  s_waitcnt lgkmcnt(2)
  v_mfma_f32_16x16x32_bf16 v[108:111], v[124:127], v[156:159], 0
  s_waitcnt lgkmcnt(0)
  v_mfma_f32_16x16x32_bf16 v[108:111], v[128:131], v[160:163], v[108:111]
L_syv2:
  ds_read_b32 v6, v12 offset:20
  ds_read_b64_tr_b16 v[132:133], v16 offset:16384
  ds_read_b64_tr_b16 v[134:135], v16 offset:20480
  ds_read_b64_tr_b16 v[136:137], v17 offset:16384
  ds_read_b64_tr_b16 v[138:139], v17 offset:20480
  s_sub_u32 s64, s64, 1
  s_cbranch_scc1 L_end
  s_waitcnt lgkmcnt(4)
  v_readfirstlane_b32 s57, v6
  s_cmp_lt_u32 s57, 3
  s_cbranch_scc1 L_syv2
  v_pk_fma_f32 v[184:185], v[108:109], v[188:189], v[184:185] op_sel:[0,1,0] op_sel_hi:[1,1,1]
  v_pk_fma_f32 v[186:187], v[110:111], v[188:189], v[186:187] op_sel:[0,1,0] op_sel_hi:[1,1,1]
  s_waitcnt lgkmcnt(2)
  v_mfma_f32_16x16x32_bf16 v[80:83], v[132:135], v[164:167], 0
  s_waitcnt lgkmcnt(0)
  v_mfma_f32_16x16x32_bf16 v[80:83], v[136:139], v[168:171], v[80:83]
L_syv3:
  ds_read_b32 v6, v12 offset:20
  ds_read_b64_tr_b16 v[140:141], v16 offset:24576
  ds_read_b64_tr_b16 v[142:143], v16 offset:28672
  ds_read_b64_tr_b16 v[144:145], v17 offset:24576
  ds_read_b64_tr_b16 v[146:147], v17 offset:28672
  s_sub_u32 s64, s64, 1
  s_cbranch_scc1 L_end
  s_waitcnt lgkmcnt(4)
  v_readfirstlane_b32 s57, v6
  s_cmp_lt_u32 s57, 4
  s_cbranch_scc1 L_syv3
  v_pk_fma_f32 v[184:185], v[80:81], v[190:191], v[184:185] op_sel:[0,0,0] op_sel_hi:[1,0,1]
  v_pk_fma_f32 v[186:187], v[82:83], v[190:191], v[186:187] op_sel:[0,0,0] op_sel_hi:[1,0,1]
  s_waitcnt lgkmcnt(2)
  v_mfma_f32_16x16x32_bf16 v[84:87], v[140:143], v[172:175], 0
  s_waitcnt lgkmcnt(0)
  v_mfma_f32_16x16x32_bf16 v[84:87], v[144:147], v[176:179], v[84:87]
  s_branch L_pvend
L_pad2:
  s_sleep 6
  s_setpc_b64 s[90:91]
L_pvall:
  ds_read_b64_tr_b16 v[116:117], v16 offset:0
  ds_read_b64_tr_b16 v[118:119], v16 offset:4096
  ds_read_b64_tr_b16 v[120:121], v17 offset:0
  ds_read_b64_tr_b16 v[122:123], v17 offset:4096
  v_exp_f32 v188, v188
  v_exp_f32 v189, v189
  v_exp_f32 v190, v190
  v_exp_f32 v191, v191
  v_mov_b32 v199, s32
  v_pk_mul_f32 v[192:193], v[192:193], v[188:189]
  v_pk_fma_f32 v[192:193], v[194:195], v[190:191], v[192:193]
  v_add_f32 v192, v192, v193
  v_rcp_f32 v194, v192
  v_log_f32 v193, v192
  s_mov_b32 s65, 24
  v_pk_mul_f32 v[188:189], v[188:189], v[194:195] op_sel_hi:[1,0]
  v_pk_mul_f32 v[190:191], v[190:191], v[194:195] op_sel_hi:[1,0]
  v_add_f32 v198, v7, v193
  s_waitcnt lgkmcnt(4)
  ds_read_b64_tr_b16 v[124:125], v16 offset:8192
  ds_read_b64_tr_b16 v[126:127], v16 offset:12288
  ds_read_b64_tr_b16 v[128:129], v17 offset:8192
  ds_read_b64_tr_b16 v[130:131], v17 offset:12288
  ds_read_b64_tr_b16 v[132:133], v16 offset:16384
  ds_read_b64_tr_b16 v[134:135], v16 offset:20480
  ds_read_b64_tr_b16 v[136:137], v17 offset:16384
  ds_read_b64_tr_b16 v[138:139], v17 offset:20480
  s_waitcnt lgkmcnt(10)
  v_mfma_f32_16x16x32_bf16 v[104:107], v[116:119], v[148:151], 0
  s_waitcnt lgkmcnt(8)
  v_mfma_f32_16x16x32_bf16 v[104:107], v[120:123], v[152:155], v[104:107]
  ds_read_b64_tr_b16 v[140:141], v16 offset:24576
  ds_read_b64_tr_b16 v[142:143], v16 offset:28672
  ds_read_b64_tr_b16 v[144:145], v17 offset:24576
  ds_read_b64_tr_b16 v[146:147], v17 offset:28672
  s_waitcnt lgkmcnt(10)
  v_mfma_f32_16x16x32_bf16 v[108:111], v[124:127], v[156:159], 0
  s_waitcnt lgkmcnt(8)
  v_mfma_f32_16x16x32_bf16 v[108:111], v[128:131], v[160:163], v[108:111]
  s_waitcnt lgkmcnt(6)
  v_mfma_f32_16x16x32_bf16 v[80:83], v[132:135], v[164:167], 0
  s_waitcnt lgkmcnt(4)
  v_mfma_f32_16x16x32_bf16 v[80:83], v[136:139], v[168:171], v[80:83]
  s_waitcnt lgkmcnt(2)
  v_mfma_f32_16x16x32_bf16 v[84:87], v[140:143], v[172:175], 0
  s_waitcnt lgkmcnt(0)
  v_mfma_f32_16x16x32_bf16 v[84:87], v[144:147], v[176:179], v[84:87]
  v_pk_mul_f32 v[184:185], v[104:105], v[188:189] op_sel:[0,0] op_sel_hi:[1,0]
  v_pk_mul_f32 v[186:187], v[106:107], v[188:189] op_sel:[0,0] op_sel_hi:[1,0]
  v_pk_fma_f32 v[184:185], v[108:109], v[188:189], v[184:185] op_sel:[0,1,0] op_sel_hi:[1,1,1]
  v_pk_fma_f32 v[186:187], v[110:111], v[188:189], v[186:187] op_sel:[0,1,0] op_sel_hi:[1,1,1]
  v_pk_fma_f32 v[184:185], v[80:81], v[190:191], v[184:185] op_sel:[0,0,0] op_sel_hi:[1,0,1]
  v_pk_fma_f32 v[186:187], v[82:83], v[190:191], v[186:187] op_sel:[0,0,0] op_sel_hi:[1,0,1]
L_pvend:
  s_mov_b64 exec, s[44:45]
  s_nop 5
  v_pk_fma_f32 v[184:185], v[84:85], v[190:191], v[184:185] op_sel:[0,1,0] op_sel_hi:[1,1,1]
  v_pk_fma_f32 v[186:187], v[86:87], v[190:191], v[186:187] op_sel:[0,1,0] op_sel_hi:[1,1,1]
  v_cvt_pk_bf16_f32 v196, v184, v185
  v_cvt_pk_bf16_f32 v197, v186, v187
  global_store_dwordx4 v35, v[196:199], s[30:31]
  s_mov_b64 exec, -1
  s_mov_b64 exec, 1
L_sy3:
  ds_read_b32 v6, v12 offset:12
  s_sub_u32 s64, s64, 1
  s_cbranch_scc1 L_end
  s_waitcnt lgkmcnt(0)
  v_readfirstlane_b32 s57, v6
  s_cmp_lt_u32 s57, 1
  s_cbranch_scc1 L_sy3
  s_mov_b64 exec, -1
  global_load_dwordx4 v[40:43], v36, s[30:31] offset:0 sc1
  global_load_dwordx4 v[44:47], v36, s[30:31] offset:512 sc1
  global_load_dwordx4 v[48:51], v36, s[30:31] offset:1024 sc1
  global_load_dwordx4 v[52:55], v36, s[30:31] offset:1536 sc1
  s_mov_b32 s65, 24
  s_mov_b32 s59, 0
L_ochk:
  s_waitcnt vmcnt(0)
  v_cmp_ne_u32 s[52:53], s32, v43
  v_cmp_ne_u32 s[54:55], s32, v47
  v_cmp_ne_u32 s[42:43], s32, v51
  v_cmp_ne_u32 s[46:47], s32, v55
  s_or_b64 vcc, s[52:53], s[54:55]
  s_or_b64 exec, s[42:43], s[46:47]
  s_or_b64 vcc, vcc, exec
  s_mov_b64 exec, -1
  s_cbranch_vccz L_ookA
  s_sub_u32 s65, s65, 1
  s_cmp_gt_i32 s65, 0
  s_cbranch_scc0 L_slow2
L_ochkr:
  s_mov_b64 exec, s[52:53]
  s_cbranch_execz L_osk0
  global_load_dwordx4 v[40:43], v36, s[30:31] offset:0 sc1
L_osk0:
  s_mov_b64 exec, s[54:55]
  s_cbranch_execz L_osk1
  global_load_dwordx4 v[44:47], v36, s[30:31] offset:512 sc1
L_osk1:
  s_mov_b64 exec, s[42:43]
  s_cbranch_execz L_osk2
  global_load_dwordx4 v[48:51], v36, s[30:31] offset:1024 sc1
L_osk2:
  s_mov_b64 exec, s[46:47]
  s_cbranch_execz L_osk3
  global_load_dwordx4 v[52:55], v36, s[30:31] offset:1536 sc1
L_osk3:
  s_mov_b64 exec, -1
  s_sub_u32 s40, s40, 1
  s_cbranch_scc0 L_ochk
  s_endpgm
L_pad3:
  s_sleep 6
  s_setpc_b64 s[90:91]
L_ookA:
  ds_read_b32 v11, v12 offset:24
  v_max3_f32 v6, v42, v46, v50
  v_max_f32 v6, v6, v54
  v_mov_b32 v7, v6
  v_lshlrev_b32 v56, 16, v40
  v_and_b32 v57, s62, v40
  v_lshlrev_b32 v58, 16, v41
  v_and_b32 v59, s62, v41
  v_permlane32_swap_b32 v6, v7
  v_max_f32 v6, v6, v7
  v_sub_f32 v42, v42, v6
  v_sub_f32 v46, v46, v6
  v_sub_f32 v50, v50, v6
  v_sub_f32 v54, v54, v6
  v_exp_f32 v42, v42
  v_exp_f32 v46, v46
  v_exp_f32 v50, v50
  v_exp_f32 v54, v54
  v_lshlrev_b32 v60, 16, v44
  v_and_b32 v61, s62, v44
  v_lshlrev_b32 v62, 16, v45
  v_and_b32 v63, s62, v45
  v_lshlrev_b32 v64, 16, v48
  v_and_b32 v65, s62, v48
  v_lshlrev_b32 v66, 16, v49
  v_and_b32 v67, s62, v49
  s_waitcnt lgkmcnt(0)
  v_readfirstlane_b32 s57, v11
  v_lshlrev_b32 v68, 16, v52
  v_and_b32 v69, s62, v52
  v_lshlrev_b32 v70, 16, v53
  v_and_b32 v71, s62, v53
  s_cmp_lt_u32 s57, 2
  s_cbranch_scc1 L_nopre40
  ds_read_b128 v[164:167], v27 offset:0
  ds_read_b64_tr_b16 v[132:133], v18 offset:16384
  ds_read_b64_tr_b16 v[134:135], v18 offset:16896
  ds_read_b128 v[168:171], v27 offset:64
  ds_read_b64_tr_b16 v[136:137], v18 offset:20480
  ds_read_b64_tr_b16 v[138:139], v18 offset:20992
  ds_read_b64_tr_b16 v[116:117], v18 offset:0
  ds_read_b64_tr_b16 v[118:119], v18 offset:512
  ds_read_b64_tr_b16 v[120:121], v18 offset:4096
  ds_read_b64_tr_b16 v[122:123], v18 offset:4608
  ds_read_b64_tr_b16 v[124:125], v18 offset:8192
  ds_read_b64_tr_b16 v[126:127], v18 offset:8704
  ds_read_b64_tr_b16 v[128:129], v18 offset:12288
  ds_read_b64_tr_b16 v[130:131], v18 offset:12800
  s_mov_b32 s59, 1
L_nopre40:
  v_add_f32 v8, v42, v46
  v_add_f32 v9, v50, v54
  v_pk_mul_f32 v[104:105], v[56:57], v[42:43] op_sel_hi:[1,0]
  v_add_f32 v8, v8, v9
  v_pk_mul_f32 v[106:107], v[58:59], v[42:43] op_sel_hi:[1,0]
  v_mov_b32 v9, v8
  v_pk_fma_f32 v[104:105], v[60:61], v[46:47], v[104:105] op_sel_hi:[1,0,1]
  v_pk_fma_f32 v[106:107], v[62:63], v[46:47], v[106:107] op_sel_hi:[1,0,1]
  v_permlane32_swap_b32 v8, v9
  v_add_f32 v8, v8, v9
  v_pk_fma_f32 v[104:105], v[64:65], v[50:51], v[104:105] op_sel_hi:[1,0,1]
  v_pk_fma_f32 v[106:107], v[66:67], v[50:51], v[106:107] op_sel_hi:[1,0,1]
  v_rcp_f32 v8, v8
  v_pk_fma_f32 v[104:105], v[68:69], v[54:55], v[104:105] op_sel_hi:[1,0,1]
  v_pk_fma_f32 v[106:107], v[70:71], v[54:55], v[106:107] op_sel_hi:[1,0,1]
  s_nop 1
  v_permlane32_swap_b32 v104, v106
  v_permlane32_swap_b32 v105, v107
  v_pk_add_f32 v[104:105], v[104:105], v[106:107]
  v_pk_mul_f32 v[104:105], v[104:105], v[8:9] op_sel_hi:[1,0]
  v_cvt_pk_bf16_f32 v104, v104, v105
  ds_write_b32 v28, v104 offset:2624
L_odone:
  s_mov_b64 exec, 1
  ds_add_u32 v12, v13 offset:28
  s_mov_b64 exec, -1
  s_cmp_eq_u32 s59, 0
  s_cbranch_scc0 L_havepre
  s_mov_b64 exec, 1
L_sy6:
  ds_read_b32 v6, v12 offset:24
  s_sub_u32 s64, s64, 1
  s_cbranch_scc1 L_end
  s_and_b32 s57, s64, 0x3ff
  s_cbranch_scc0 L_slow3
  s_waitcnt lgkmcnt(0)
  v_readfirstlane_b32 s57, v6
  s_cmp_lt_u32 s57, 2
  s_cbranch_scc1 L_sy6
  s_mov_b64 exec, -1
  ds_read_b128 v[164:167], v27 offset:0
  ds_read_b64_tr_b16 v[132:133], v18 offset:16384
  ds_read_b64_tr_b16 v[134:135], v18 offset:16896
  ds_read_b128 v[168:171], v27 offset:64
  ds_read_b64_tr_b16 v[136:137], v18 offset:20480
  ds_read_b64_tr_b16 v[138:139], v18 offset:20992
  ds_read_b64_tr_b16 v[116:117], v18 offset:0
  ds_read_b64_tr_b16 v[118:119], v18 offset:512
  ds_read_b64_tr_b16 v[120:121], v18 offset:4096
  ds_read_b64_tr_b16 v[122:123], v18 offset:4608
  ds_read_b64_tr_b16 v[124:125], v18 offset:8192
  ds_read_b64_tr_b16 v[126:127], v18 offset:8704
  ds_read_b64_tr_b16 v[128:129], v18 offset:12288
  ds_read_b64_tr_b16 v[130:131], v18 offset:12800
  s_mov_b32 s59, 1
L_havepre:
  s_waitcnt lgkmcnt(8)
  v_mfma_f32_16x16x32_bf16 v[180:183], v[132:135], v[164:167], 0
  v_mfma_f32_16x16x32_bf16 v[180:183], v[136:139], v[168:171], v[180:183]
  s_waitcnt lgkmcnt(0)
L_sy7:
  ds_read_b32 v6, v12 offset:28
  ds_read2_b32 v[8:9], v12 offset0:8 offset1:10
  ds_read_b128 v[148:151], v26 offset:0
  ds_read_b128 v[152:155], v26 offset:64
  ds_read_b128 v[156:159], v26 offset:128
  ds_read_b128 v[160:163], v26 offset:192
  s_sub_u32 s64, s64, 1
  s_cbranch_scc1 L_end
  s_and_b32 s57, s64, 0x3ff
  s_cbranch_scc0 L_slow4
  s_waitcnt lgkmcnt(5)
  v_readfirstlane_b32 s57, v6
  s_cmp_lt_u32 s57, 4
  s_cbranch_scc1 L_sy7
  s_waitcnt lgkmcnt(3)
  v_mfma_f32_16x16x32_bf16 v[180:183], v[116:119], v[148:151], v[180:183]
  s_waitcnt lgkmcnt(2)
  v_mfma_f32_16x16x32_bf16 v[180:183], v[120:123], v[152:155], v[180:183]
  s_waitcnt lgkmcnt(1)
  v_mfma_f32_16x16x32_bf16 v[180:183], v[124:127], v[156:159], v[180:183]
  s_waitcnt lgkmcnt(0)
  v_mfma_f32_16x16x32_bf16 v[180:183], v[128:131], v[160:163], v[180:183]
  s_mov_b64 exec, s[44:45]
  v_xor_b32 v37, v8, v37
  v_xor_b32 v6, 0x2000, v37
  s_nop 4
  v_and_or_b32 v180, v180, v15, s33
  v_and_or_b32 v181, v181, v15, s34
  v_and_or_b32 v182, v182, v15, s35
  v_and_or_b32 v183, v183, v15, s36
  global_store_dwordx4 v37, v[180:183], s[30:31] sc1
  global_store_dwordx4 v6, v[180:183], s[30:31] sc1
  s_mov_b64 exec, -1
  v_readfirstlane_b32 s57, v9
  s_cmp_eq_u32 s57, 0
  s_cbranch_scc1 L_qdone
  v_add_u32 v10, 4194304, v33
  s_mov_b64 exec, s[48:49]
  global_store_dwordx4 v10, v[200:203], s[30:31] sc1
  s_mov_b64 exec, -1
  v_add_u32 v10, 4194304, v34
  s_mov_b64 exec, s[48:49]
  global_store_dwordx4 v10, v[204:207], s[30:31] sc1
  s_mov_b64 exec, -1
  v_add_u32 v10, 4194304, v35
  s_mov_b64 exec, s[44:45]
  global_store_dwordx4 v10, v[196:199], s[30:31] sc1
  s_mov_b64 exec, -1
L_qdone:
  s_endpgm
L_pad4:
  s_sleep 6
  s_setpc_b64 s[90:91]
L_FIN:
  s_lshr_b32 s57, s5, 1
  s_lshl_b32 s57, s57, 3
  s_add_u32 s57, s57, s4
  s_and_b32 s58, s5, 1
  s_bfe_u32 s56, s57, 0x20002
  s_lshl_b32 s56, s56, 9
  s_lshr_b32 s60, s57, 4
  s_lshl_b32 s60, s60, 6
  s_add_u32 s56, s56, s60
  s_and_b32 s60, s57, 3
  s_lshl_b32 s60, s60, 4
  s_add_u32 s56, s56, s60
  s_lshl_b32 s60, s58, 3
  s_add_u32 s56, s56, s60
  v_and_b32 v6, 1, v0
  v_lshl_add_u32 v6, v6, 2, v1
  v_add_lshl_u32 v12, v6, s56, 1
  global_load_ushort v13, v12, s[8:9]
  s_and_b32 s60, s57, 1
  s_lshr_b32 s57, s57, 1
  s_lshl2_add_u32 s57, s57, s60
  s_lshr_b32 s60, s4, 2
  s_xor_b32 s60, s60, 0
  s_mov_b32 s60, 0
  s_lshl1_add_u32 s57, s60, s57
  s_lshl_b32 s56, s57, 12
  s_lshl_b32 s60, s58, 6
  s_add_u32 s56, s56, s60
  s_add_u32 s56, s56, 2621440
  v_lshrrev_b32 v6, 2, v0
  v_and_b32 v14, 3, v0
  v_lshlrev_b32 v14, 4, v14
  v_lshl_add_u32 v14, v6, 7, v14
  v_add_u32 v14, s56, v14
  s_mov_b32 s40, 262144
  s_mov_b32 s62, 0xffff0000
  s_waitcnt lgkmcnt(0)
  s_add_u32 s32, s32, 0x9e3779b1
  s_and_b32 s33, s32, 0xff
  s_bfe_u32 s34, s32, 0x80008
  s_bfe_u32 s35, s32, 0x80010
  s_lshr_b32 s36, s32, 24
  v_mov_b32 v17, s32
  s_waitcnt vmcnt(11)
  s_mov_b64 exec, 1
  ds_add_u32 v15, v16 offset:12
  s_mov_b64 exec, -1
  s_waitcnt vmcnt(1)
  s_mov_b64 exec, 1
  ds_add_u32 v15, v16 offset:24
  s_mov_b64 exec, -1
L_dw:
  ds_read_b32 v6, v15 offset:28
  s_sub_u32 s64, s64, 1
  s_cbranch_scc1 L_end
  s_waitcnt lgkmcnt(0)
  v_readfirstlane_b32 s56, v6
  s_cmp_lt_u32 s56, 4
  s_cbranch_scc1 L_dw
  ds_read_b32 v6, v15 offset:32
  s_waitcnt lgkmcnt(0)
  v_add_u32 v14, v6, v14
  s_waitcnt vmcnt(0)
  v_lshlrev_b32 v13, 16, v13
  s_mov_b32 s42, 0x00030003
  s_mov_b32 s43, 0x00030003
  s_sleep 15
  global_load_dwordx4 v[20:23], v14, s[30:31] offset:0 sc1
  global_load_dwordx4 v[24:27], v14, s[30:31] offset:2048 sc1
L_dpoll:
  s_waitcnt vmcnt(0)
  v_xor_b32 v20, s33, v20
  v_xor_b32 v21, s34, v21
  v_xor_b32 v22, s35, v22
  v_xor_b32 v23, s36, v23
  v_xor_b32 v24, s33, v24
  v_xor_b32 v25, s34, v25
  v_xor_b32 v26, s35, v26
  v_xor_b32 v27, s36, v27
  v_or3_b32 v7, v20, v21, v22
  v_or3_b32 v7, v7, v23, v24
  v_or3_b32 v7, v7, v25, v26
  v_or_b32 v7, v7, v27
  v_and_b32 v7, 0xff, v7
  v_cmp_ne_u32 vcc, 0, v7
  s_cbranch_vccz L_dok0
  global_load_dwordx4 v[20:23], v14, s[30:31] offset:0 sc1
  global_load_dwordx4 v[24:27], v14, s[30:31] offset:2048 sc1
  s_sub_u32 s40, s40, 1
  s_cbranch_scc0 L_dpoll
  s_endpgm
L_pad5:
  s_sleep 6
  s_setpc_b64 s[90:91]
L_dok0:
  v_pk_add_f32 v[20:21], v[20:21], v[24:25]
  v_pk_add_f32 v[22:23], v[22:23], v[26:27]
L_dsum0:
  s_nop 0
  v_add_f32_dpp v40, v20, v20 row_ror:4 row_mask:0xf bank_mask:0xf
  v_add_f32_dpp v41, v21, v21 row_ror:4 row_mask:0xf bank_mask:0xf
  v_add_f32_dpp v42, v22, v22 row_ror:4 row_mask:0xf bank_mask:0xf
  v_add_f32_dpp v43, v23, v23 row_ror:4 row_mask:0xf bank_mask:0xf
L_dfin:
  s_cmp_eq_u32 s2, 0
  s_cbranch_scc0 L_noep
  s_mov_b64 exec, 1
  v_mov_b32 v6, 0
  global_store_dword v6, v17, s[30:31]
  s_mov_b64 exec, -1
L_noep:
  v_add_f32_dpp v40, v40, v40 row_ror:8 row_mask:0xf bank_mask:0xf
  v_add_f32_dpp v41, v41, v41 row_ror:8 row_mask:0xf bank_mask:0xf
  v_add_f32_dpp v42, v42, v42 row_ror:8 row_mask:0xf bank_mask:0xf
  v_add_f32_dpp v43, v43, v43 row_ror:8 row_mask:0xf bank_mask:0xf
  s_nop 1
  v_permlane16_swap_b32 v40, v41
  v_permlane16_swap_b32 v42, v43
  v_add_f32 v40, v40, v41
  v_add_f32 v42, v42, v43
  s_nop 1
  v_permlane32_swap_b32 v40, v42
  v_add_f32 v40, v40, v42
  v_cvt_pk_bf16_f32 v40, v40, v40
  v_and_b32 v40, s62, v40
  v_mul_f32 v41, 0xbfb8aa3b, v40
  v_exp_f32 v41, v41
  s_nop 0
  v_add_f32 v41, 1.0, v41
  v_rcp_f32 v41, v41
  s_nop 0
  v_mul_f32 v41, v41, v40
  v_cvt_pk_bf16_f32 v41, v41, v41
  v_and_b32 v41, s62, v41
  s_nop 1
  v_mul_f32_dpp v41, v41, v40 quad_perm:[2,3,0,1] row_mask:0xf bank_mask:0xf
  v_cvt_pk_bf16_f32 v41, v41, v41
  v_and_b32 v41, s62, v41
  v_add_f32 v41, v13, v41
  v_cvt_pk_bf16_f32 v41, v41, v41
  s_mov_b64 exec, s[42:43]
  global_store_short v12, v41, s[26:27]
L_lend:
  s_endpgm
L_end:
  s_endpgm
L_PR:
  s_barrier
  s_cmp_eq_u32 s2, 1
  s_cbranch_scc1 L_PR1
  s_sleep 40
  s_getpc_b64 s[88:89]
L_tc0:
  s_add_u32 s88, s88, L_pad0-L_tc0
  s_addc_u32 s89, s89, -1
  s_swappc_b64 s[90:91], s[88:89]
  s_getpc_b64 s[88:89]
L_tc1:
  s_add_u32 s88, s88, L_pad1-L_tc1
  s_addc_u32 s89, s89, -1
  s_swappc_b64 s[90:91], s[88:89]
  s_getpc_b64 s[88:89]
L_tc2:
  s_add_u32 s88, s88, L_pad2-L_tc2
  s_addc_u32 s89, s89, -1
  s_swappc_b64 s[90:91], s[88:89]
  s_getpc_b64 s[88:89]
L_tc3:
  s_add_u32 s88, s88, L_pad3-L_tc3
  s_addc_u32 s89, s89, -1
  s_swappc_b64 s[90:91], s[88:89]
  s_getpc_b64 s[88:89]
L_tc4:
  s_add_u32 s88, s88, L_pad4-L_tc4
  s_addc_u32 s89, s89, -1
  s_swappc_b64 s[90:91], s[88:89]
  s_getpc_b64 s[88:89]
L_tc5:
  s_add_u32 s88, s88, L_pad5-L_tc5
  s_addc_u32 s89, s89, -1
  s_swappc_b64 s[90:91], s[88:89]
  s_endpgm
L_PR1:
  s_getreg_b32 s37, hwreg(HW_REG_XCC_ID)
  s_bfe_u32 s37, s37, 0x10002
  s_waitcnt lgkmcnt(0)
  s_load_dword s32, s[30:31], 0
  s_add_u32 s42, s30, 3670016
  s_addc_u32 s43, s31, 0
  s_load_dword s70, s[42:43], 0 glc
  s_load_dword s71, s[42:43], 576 glc
  s_load_dword s72, s[42:43], 1152 glc
  s_load_dword s73, s[42:43], 1728 glc
  s_load_dword s74, s[42:43], 2304 glc
  s_load_dword s75, s[42:43], 2880 glc
  s_load_dword s78, s[42:43], 8192 glc
  s_load_dword s79, s[42:43], 8768 glc
  s_load_dword s80, s[42:43], 9344 glc
  s_load_dword s81, s[42:43], 9920 glc
  s_load_dword s82, s[42:43], 10496 glc
  s_load_dword s83, s[42:43], 11072 glc
  s_waitcnt lgkmcnt(0)
  s_add_u32 s32, s32, 0x9e3779b1
  s_mov_b32 s58, -1
  s_mov_b32 s59, -1
  s_mov_b32 s57, 1
L_probe:
  s_memtime s[44:45]
  s_waitcnt lgkmcnt(0)
  s_load_dword s70, s[42:43], 0 glc
  s_load_dword s71, s[42:43], 576 glc
  s_load_dword s72, s[42:43], 1152 glc
  s_load_dword s73, s[42:43], 1728 glc
  s_load_dword s74, s[42:43], 2304 glc
  s_load_dword s75, s[42:43], 2880 glc
  s_waitcnt lgkmcnt(5)
  s_memtime s[46:47]
  s_waitcnt lgkmcnt(0)
  s_sub_u32 s56, s46, s44
  s_min_u32 s58, s58, s56
  s_memtime s[44:45]
  s_waitcnt lgkmcnt(0)
  s_load_dword s70, s[42:43], 8192 glc
  s_load_dword s71, s[42:43], 8768 glc
  s_load_dword s72, s[42:43], 9344 glc
  s_load_dword s73, s[42:43], 9920 glc
  s_load_dword s74, s[42:43], 10496 glc
  s_load_dword s75, s[42:43], 11072 glc
  s_waitcnt lgkmcnt(5)
  s_memtime s[46:47]
  s_waitcnt lgkmcnt(0)
  s_sub_u32 s56, s46, s44
  s_min_u32 s59, s59, s56
  s_sub_u32 s57, s57, 1
  s_cmp_lg_u32 s57, 0
  s_cbranch_scc1 L_probe
  s_cmp_gt_u32 s58, s59
  s_cselect_b32 s56, 1, 0
  s_xor_b32 s56, s56, s37
  s_andn2_b32 s57, s32, 1
  s_or_b32 s56, s56, s57
  v_mov_b32 v2, 128
  v_mov_b32 v3, s56
  s_mov_b64 exec, 1
  global_store_dword v2, v3, s[30:31] sc1
  s_endpgm
L_slow0:
  s_mov_b64 exec, -1
  s_cmp_eq_u32 s65, 0
  s_cbranch_scc0 L_slowr0
  v_add_u32 v10, 4194304, v33
  s_mov_b64 exec, s[48:49]
  global_store_dwordx4 v10, v[200:203], s[30:31] sc1
  s_mov_b64 exec, -1
  v_add_u32 v10, 4194304, v34
  s_mov_b64 exec, s[48:49]
  global_store_dwordx4 v10, v[204:207], s[30:31] sc1
  s_mov_b64 exec, -1
  ds_write_b32 v12, v13 offset:40
L_slowr0:
  v_xor_b32 v14, 4194304, v14
  s_xor_b32 s28, s28, s29
  s_branch L_qchkr
L_slow1:
  s_mov_b64 exec, -1
  v_add_u32 v10, 4194304, v33
  s_mov_b64 exec, s[48:49]
  global_store_dwordx4 v10, v[200:203], s[30:31] sc1
  s_mov_b64 exec, -1
  v_add_u32 v10, 4194304, v34
  s_mov_b64 exec, s[48:49]
  global_store_dwordx4 v10, v[204:207], s[30:31] sc1
  s_mov_b64 exec, -1
  s_mov_b64 exec, 1
  s_branch L_sy2
L_slow2:
  s_mov_b64 exec, -1
  s_cmp_eq_u32 s65, 0
  s_cbranch_scc0 L_slowr2
  v_add_u32 v10, 4194304, v33
  s_mov_b64 exec, s[48:49]
  global_store_dwordx4 v10, v[200:203], s[30:31] sc1
  s_mov_b64 exec, -1
  v_add_u32 v10, 4194304, v34
  s_mov_b64 exec, s[48:49]
  global_store_dwordx4 v10, v[204:207], s[30:31] sc1
  s_mov_b64 exec, -1
  v_add_u32 v10, 4194304, v35
  s_mov_b64 exec, s[44:45]
  global_store_dwordx4 v10, v[196:199], s[30:31] sc1
  s_mov_b64 exec, -1
L_slowr2:
  v_xor_b32 v36, 4194304, v36
  s_branch L_ochkr
L_slow3:
  s_mov_b64 exec, -1
  v_add_u32 v10, 4194304, v33
  s_mov_b64 exec, s[48:49]
  global_store_dwordx4 v10, v[200:203], s[30:31] sc1
  s_mov_b64 exec, -1
  v_add_u32 v10, 4194304, v34
  s_mov_b64 exec, s[48:49]
  global_store_dwordx4 v10, v[204:207], s[30:31] sc1
  s_mov_b64 exec, -1
  v_add_u32 v10, 4194304, v35
  s_mov_b64 exec, s[44:45]
  global_store_dwordx4 v10, v[196:199], s[30:31] sc1
  s_mov_b64 exec, -1
  s_mov_b64 exec, 1
  s_branch L_sy6
L_slow4:
  s_mov_b64 exec, -1
  v_add_u32 v10, 4194304, v33
  s_mov_b64 exec, s[48:49]
  global_store_dwordx4 v10, v[200:203], s[30:31] sc1
  s_mov_b64 exec, -1
  v_add_u32 v10, 4194304, v34
  s_mov_b64 exec, s[48:49]
  global_store_dwordx4 v10, v[204:207], s[30:31] sc1
  s_mov_b64 exec, -1
  v_add_u32 v10, 4194304, v35
  s_mov_b64 exec, s[44:45]
  global_store_dwordx4 v10, v[196:199], s[30:31] sc1
  s_mov_b64 exec, -1
  s_branch L_sy7
L_codeend:
.fill 256, 4, 0xbf800000
.section .rodata,"a"
.p2align 6
.amdhsa_kernel recurrent_scan__sliding_block_cached__glu_gated_swiglu__decode_kernel
  .amdhsa_next_free_vgpr 224
  .amdhsa_next_free_sgpr 100
  .amdhsa_accum_offset 224
  .amdhsa_group_segment_fixed_size 0
  .amdhsa_kernarg_size 96
  .amdhsa_user_sgpr_count 2
  .amdhsa_user_sgpr_kernarg_segment_ptr 1
  .amdhsa_system_sgpr_workgroup_id_x 1
  .amdhsa_float_denorm_mode_32 3
.end_amdhsa_kernel
```
